```python
import torch

def _softmax(x, axis=-1):
    return torch.softmax(x, dim=axis)
def _gelu(x):
    return torch.nn.functional.gelu(x, approximate="tanh")
def _silu(x):
    return torch.nn.functional.silu(x)
def _sigmoid(x):
    return torch.sigmoid(x)
def _layernorm(x, axis=-1, eps=1e-5):
    m = x.mean(dim=axis, keepdim=True)
    v = x.var(dim=axis, keepdim=True, unbiased=False)
    return (x - m) / torch.sqrt(v + eps)
def _scatter_add(tgt, idx, src, axis=0):
    return tgt.clone().index_add_(axis, idx, src)
def _segment_sum(src, seg, n):
    out = torch.zeros((n,) + src.shape[1:], dtype=src.dtype)
    return out.index_add_(0, seg, src)
def _pad(x, pw):
    flat = tuple(v for pair in reversed(pw) for v in pair)
    return torch.nn.functional.pad(x, flat)

kernel_name = 'standalone__softmax_full_bidir__sampling'

def setup_inputs():

    _w = (lambda a: (lambda t: t.to(torch.bfloat16) if t.is_floating_point() else t)(torch.as_tensor(a)))
    B, H, Sq, Skv, Dh = 8, 16, 4, 8192, 256
    return {
        "q": _w((lambda *s: torch.randn(*s, dtype=torch.bfloat16) * 0.8)(B, H, Sq, Dh)),
        "k": _w((lambda *s: torch.randn(*s, dtype=torch.bfloat16) * 0.8)(B, H, Skv, Dh)),
        "v": _w((lambda *s: torch.randn(*s, dtype=torch.bfloat16) * 0.05)(B, H, Skv, Dh)),
    }

def reference(q, k, v):
    scale = q.shape[-1] ** -0.5
    scores = torch.einsum('bhqd,bhkd->bhqk', q, k) * scale
    attn = _softmax(scores, axis=-1)
    return torch.einsum('bhqk,bhkd->bhqd', attn, v)
```

```asm
; @launch grid=(256,1,1) block=(192,1,1) lds=149600
.amdgcn_target "amdgcn-amd-amdhsa--gfx950"
.text
.globl standalone__softmax_full_bidir__sampling_kernel
.p2align 8
.type standalone__softmax_full_bidir__sampling_kernel,@function
standalone__softmax_full_bidir__sampling_kernel:
    v_lshrrev_b32 v1, 6, v0
    s_cmp_ge_u32 s2, 256
    v_readfirstlane_b32 s3, v1
    s_cbranch_scc1 L_exit
    v_mov_b32 v10, 149504
    s_cmp_lg_u32 s3, 2
    s_cbranch_scc1 L_args
    v_mov_b32 v12, 0
    v_mov_b32 v13, 80
    v_mov_b32 v14, 2
    v_mov_b32 v15, 0
    ds_write_b32 v10, v12
    ds_write_b128 v10, v[12:15] offset:16
    ds_write_b32 v10, v12 offset:52
    s_waitcnt lgkmcnt(0)
L_args:
    s_load_dwordx8 s[4:11], s[0:1], 0
    s_load_dwordx4 s[28:31], s[0:1], 32
    s_lshr_b32 s49, s2, 3
    s_and_b32 s33, s2, 3
    s_lshl2_add_u32 s33, s49, s33
    s_bfe_u32 s34, s2, 0x10002
    s_cmp_eq_u32 s3, 0
    s_cbranch_scc1 L_loader
    s_barrier
    v_and_b32 v2, 63, v0
    s_xor_b32 s32, s34, s49
    s_and_b32 s32, s32, 1
    s_cmp_eq_u32 s3, 2
    s_cbranch_scc1 L_helper
    s_branch L_consumer
L_loader:
    v_lshrrev_b32 v3, 5, v0
    v_lshlrev_b32 v9, 1, v3
    v_xor_b32 v9, v9, v0
    v_lshlrev_b32 v4, 4, v9
    v_xor_b32 v5, 64, v4
    v_xor_b32 v6, 128, v4
    v_xor_b32 v7, 192, v4
    s_lshl_b32 s35, s33, 22
    s_mov_b32 s14, 0x400000
    s_mov_b32 s15, 0x20000
    s_mov_b32 s58, 0x40000
    s_mov_b32 s59, 0x20000
    s_lshl_b32 s19, s33, 11
    s_lshl_b32 s16, s34, 21
    s_mov_b32 m0, 147456
    s_barrier
    s_waitcnt lgkmcnt(0)
    s_mov_b64 s[56:57], s[4:5]
    s_add_u32 s12, s6, s35
    s_addc_u32 s13, s7, 0
    buffer_load_dwordx4 v4, s[56:59], s19 offen nt lds
    buffer_load_dwordx4 v5, s[56:59], s19 offen offset:1024 nt lds
    s_movk_i32 m0, 0
    s_add_u32 s19, s16, 0x0
    buffer_load_dwordx4 v4, s[12:15], s19 offen nt lds
    s_movk_i32 m0, 1024
    s_add_u32 s19, s16, 0x2000
    buffer_load_dwordx4 v5, s[12:15], s19 offen nt lds
    s_movk_i32 m0, 2048
    s_add_u32 s19, s16, 0x8000
    buffer_load_dwordx4 v6, s[12:15], s19 offen nt lds
    s_movk_i32 m0, 3072
    s_add_u32 s19, s16, 0xa000
    buffer_load_dwordx4 v7, s[12:15], s19 offen nt lds
    s_movk_i32 m0, 4096
    s_add_u32 s19, s16, 0x400
    buffer_load_dwordx4 v4, s[12:15], s19 offen nt lds
    s_movk_i32 m0, 5120
    s_add_u32 s19, s16, 0x2400
    buffer_load_dwordx4 v5, s[12:15], s19 offen nt lds
    s_movk_i32 m0, 6144
    s_add_u32 s19, s16, 0x8400
    buffer_load_dwordx4 v6, s[12:15], s19 offen nt lds
    s_movk_i32 m0, 7168
    s_add_u32 s19, s16, 0xa400
    buffer_load_dwordx4 v7, s[12:15], s19 offen nt lds
    s_movk_i32 m0, 8192
    s_add_u32 s19, s16, 0x800
    buffer_load_dwordx4 v4, s[12:15], s19 offen nt lds
    s_movk_i32 m0, 9216
    s_add_u32 s19, s16, 0x2800
    buffer_load_dwordx4 v5, s[12:15], s19 offen nt lds
    s_movk_i32 m0, 10240
    s_add_u32 s19, s16, 0x8800
    buffer_load_dwordx4 v6, s[12:15], s19 offen nt lds
    s_movk_i32 m0, 11264
    s_add_u32 s19, s16, 0xa800
    buffer_load_dwordx4 v7, s[12:15], s19 offen nt lds
    s_movk_i32 m0, 12288
    s_add_u32 s19, s16, 0xc00
    buffer_load_dwordx4 v4, s[12:15], s19 offen nt lds
    s_movk_i32 m0, 13312
    s_add_u32 s19, s16, 0x2c00
    buffer_load_dwordx4 v5, s[12:15], s19 offen nt lds
    s_movk_i32 m0, 14336
    s_add_u32 s19, s16, 0x8c00
    buffer_load_dwordx4 v6, s[12:15], s19 offen nt lds
    s_movk_i32 m0, 15360
    s_add_u32 s19, s16, 0xac00
    buffer_load_dwordx4 v7, s[12:15], s19 offen nt lds
    s_setprio 3
    s_add_u32 s20, s8, s35
    s_addc_u32 s21, s9, 0
    s_mov_b32 s65, 0x2000
    s_mov_b32 s66, 0x8000
    s_mov_b32 s67, 0xa000
    s_mov_b32 s68, 0x400
    s_mov_b32 s69, 0x2400
    s_mov_b32 s70, 0x8400
    s_mov_b32 s71, 0xa400
    s_mov_b32 s72, 0x800
    s_mov_b32 s73, 0x2800
    s_mov_b32 s74, 0x8800
    s_mov_b32 s75, 0xa800
    s_mov_b32 s76, 0xc00
    s_mov_b32 s77, 0x2c00
    s_mov_b32 s78, 0x8c00
    s_mov_b32 s79, 0xac00
    s_mov_b32 s80, 0x1000
    s_mov_b32 s81, 0x4000
    s_lshl_b32 s82, s34, 21
    s_mov_b32 s83, 15
    s_mov_b32 s44, 0
    s_mov_b32 s22, 1
    s_xor_b32 s16, s16, s80
    s_mov_b32 s18, 16384
    s_bfe_u32 s41, s33, 0x10006
    s_mul_i32 s41, s41, 16
    s_and_b32 s47, s49, 3
    s_mov_b32 s40, 4194304
L_w20:
    s_add_u32 m0, s18, 0
    s_mov_b32 s19, s16
    s_waitcnt vmcnt(19)
    buffer_load_dwordx4 v4, s[12:15], s19 offen nt lds
    s_add_u32 m0, s18, 1024
    s_add_u32 s19, s16, s65
    s_waitcnt vmcnt(19)
    buffer_load_dwordx4 v5, s[12:15], s19 offen nt lds
    s_add_u32 m0, s18, 2048
    s_add_u32 s19, s16, s66
    s_waitcnt vmcnt(19)
    buffer_load_dwordx4 v6, s[12:15], s19 offen nt lds
    s_add_u32 m0, s18, 3072
    s_add_u32 s19, s16, s67
    s_waitcnt vmcnt(19)
    buffer_load_dwordx4 v7, s[12:15], s19 offen nt lds
    s_add_u32 s24, s22, -1
    v_mov_b32 v11, s24
    ds_write_b32 v10, v11
    s_add_u32 s23, s22, 1
    s_bfe_u32 s37, s23, 0x50002
    s_bitcmp1_b32 s23, 7
    s_cselect_b32 s39, s41, 0
    s_cselect_b32 s36, 22, 20
    s_add_u32 m0, s18, 4096
    s_add_u32 s19, s16, s68
    s_waitcnt vmcnt(19)
    buffer_load_dwordx4 v4, s[12:15], s19 offen nt lds
    s_xor_b32 s37, s37, s39
    s_lshl_b32 s17, s37, 16
    s_xor_b32 s17, s17, s82
    s_add_u32 m0, s18, 5120
    s_add_u32 s19, s16, s69
    s_waitcnt vmcnt(19)
    buffer_load_dwordx4 v5, s[12:15], s19 offen nt lds
    s_bitcmp1_b32 s23, 0
    s_cselect_b32 s39, s80, 0
    s_xor_b32 s17, s17, s39
    s_add_u32 m0, s18, 6144
    s_add_u32 s19, s16, s70
    s_waitcnt vmcnt(19)
    buffer_load_dwordx4 v6, s[12:15], s19 offen nt lds
    s_bitcmp1_b32 s23, 1
    s_cselect_b32 s39, s81, 0
    s_xor_b32 s17, s17, s39
    s_add_u32 m0, s18, 7168
    s_add_u32 s19, s16, s71
    s_waitcnt vmcnt(19)
    buffer_load_dwordx4 v7, s[12:15], s19 offen nt lds
    s_add_u32 s27, s18, 16384
    s_cmp_eq_u32 s27, 81920
    s_cselect_b32 s27, 0, s27
    s_add_u32 m0, s18, 8192
    s_add_u32 s19, s16, s72
    s_waitcnt vmcnt(19)
    buffer_load_dwordx4 v4, s[12:15], s19 offen nt lds
    s_add_u32 m0, s18, 9216
    s_add_u32 s19, s16, s73
    s_waitcnt vmcnt(19)
    buffer_load_dwordx4 v5, s[12:15], s19 offen nt lds
    ds_read_b128 v[12:15], v10 offset:16
    s_add_u32 m0, s18, 10240
    s_add_u32 s19, s16, s74
    s_waitcnt vmcnt(19)
    buffer_load_dwordx4 v6, s[12:15], s19 offen nt lds
    s_add_u32 m0, s18, 11264
    s_add_u32 s19, s16, s75
    s_waitcnt vmcnt(19)
    buffer_load_dwordx4 v7, s[12:15], s19 offen nt lds
    s_waitcnt lgkmcnt(0)
    v_readfirstlane_b32 s25, v12
    v_readfirstlane_b32 s26, v13
    v_readfirstlane_b32 s43, v14
    s_add_u32 m0, s18, 12288
    s_add_u32 s19, s16, s76
    s_waitcnt vmcnt(19)
    buffer_load_dwordx4 v4, s[12:15], s19 offen nt lds
    s_add_u32 s47, s47, s26
    s_andn2_b32 s26, s47, s83
    s_and_b32 s47, s47, s83
    s_lshr_b32 s26, s26, 2
    s_add_u32 m0, s18, 13312
    s_add_u32 s19, s16, s77
    s_waitcnt vmcnt(19)
    buffer_load_dwordx4 v5, s[12:15], s19 offen nt lds
    s_add_u32 s25, s25, 5
    s_cmp_ge_u32 s37, 5
    s_cselect_b32 s45, s43, 0
    s_add_u32 m0, s18, 14336
    s_add_u32 s19, s16, s78
    s_waitcnt vmcnt(19)
    buffer_load_dwordx4 v6, s[12:15], s19 offen nt lds
    s_cmp_lg_u32 s45, s43
    s_cselect_b32 s26, s36, s26
    s_add_u32 m0, s18, 15360
    s_add_u32 s19, s16, s79
    s_waitcnt vmcnt(19)
    buffer_load_dwordx4 v7, s[12:15], s19 offen nt lds
    s_cmp_gt_u32 s25, s23
    s_cbranch_scc0 L_wait
L_next:
    s_bitcmp1_b32 s23, 8
    s_cbranch_scc1 L_drain
    s_cmp_lg_u32 s45, s44
    s_cbranch_scc1 L_switch
L_next2:
    s_cmp_eq_u32 s23, 128
    s_cselect_b64 s[12:13], s[20:21], s[12:13]
    s_mov_b32 s22, s23
    s_mov_b32 s16, s17
    s_mov_b32 s18, s27
    s_cmp_eq_u32 s26, 20
    s_cbranch_scc1 L_w20
    s_cmp_eq_u32 s26, 18
    s_cbranch_scc1 L_w18
    s_cmp_eq_u32 s26, 22
    s_cbranch_scc1 L_w22
    s_cmp_eq_u32 s26, 16
    s_cbranch_scc1 L_w16
    s_cmp_eq_u32 s26, 24
    s_cbranch_scc1 L_w24
    s_branch L_w20
L_w16:
    s_add_u32 m0, s18, 0
    s_mov_b32 s19, s16
    s_waitcnt vmcnt(15)
    buffer_load_dwordx4 v4, s[12:15], s19 offen nt lds
    s_add_u32 s24, s22, -1
    v_mov_b32 v11, s24
    ds_write_b32 v10, v11
    s_add_u32 m0, s18, 1024
    s_add_u32 s19, s16, s65
    s_waitcnt vmcnt(15)
    buffer_load_dwordx4 v5, s[12:15], s19 offen nt lds
    s_add_u32 m0, s18, 2048
    s_add_u32 s19, s16, s66
    s_waitcnt vmcnt(15)
    buffer_load_dwordx4 v6, s[12:15], s19 offen nt lds
    s_add_u32 m0, s18, 3072
    s_add_u32 s19, s16, s67
    s_waitcnt vmcnt(15)
    buffer_load_dwordx4 v7, s[12:15], s19 offen nt lds
    s_add_u32 s23, s22, 1
    s_bfe_u32 s37, s23, 0x50002
    s_bitcmp1_b32 s23, 7
    s_cselect_b32 s39, s41, 0
    s_cselect_b32 s36, 22, 20
    s_add_u32 m0, s18, 4096
    s_add_u32 s19, s16, s68
    s_waitcnt vmcnt(15)
    buffer_load_dwordx4 v4, s[12:15], s19 offen nt lds
    s_xor_b32 s37, s37, s39
    s_lshl_b32 s17, s37, 16
    s_xor_b32 s17, s17, s82
    s_add_u32 m0, s18, 5120
    s_add_u32 s19, s16, s69
    s_waitcnt vmcnt(15)
    buffer_load_dwordx4 v5, s[12:15], s19 offen nt lds
    s_bitcmp1_b32 s23, 0
    s_cselect_b32 s39, s80, 0
    s_xor_b32 s17, s17, s39
    s_add_u32 m0, s18, 6144
    s_add_u32 s19, s16, s70
    s_waitcnt vmcnt(15)
    buffer_load_dwordx4 v6, s[12:15], s19 offen nt lds
    s_bitcmp1_b32 s23, 1
    s_cselect_b32 s39, s81, 0
    s_xor_b32 s17, s17, s39
    s_add_u32 m0, s18, 7168
    s_add_u32 s19, s16, s71
    s_waitcnt vmcnt(15)
    buffer_load_dwordx4 v7, s[12:15], s19 offen nt lds
    s_add_u32 s27, s18, 16384
    s_cmp_eq_u32 s27, 81920
    s_cselect_b32 s27, 0, s27
    s_add_u32 m0, s18, 8192
    s_add_u32 s19, s16, s72
    s_waitcnt vmcnt(15)
    buffer_load_dwordx4 v4, s[12:15], s19 offen nt lds
    s_add_u32 m0, s18, 9216
    s_add_u32 s19, s16, s73
    s_waitcnt vmcnt(15)
    buffer_load_dwordx4 v5, s[12:15], s19 offen nt lds
    ds_read_b128 v[12:15], v10 offset:16
    s_add_u32 m0, s18, 10240
    s_add_u32 s19, s16, s74
    s_waitcnt vmcnt(15)
    buffer_load_dwordx4 v6, s[12:15], s19 offen nt lds
    s_add_u32 m0, s18, 11264
    s_add_u32 s19, s16, s75
    s_waitcnt vmcnt(15)
    buffer_load_dwordx4 v7, s[12:15], s19 offen nt lds
    s_waitcnt lgkmcnt(0)
    v_readfirstlane_b32 s25, v12
    v_readfirstlane_b32 s26, v13
    v_readfirstlane_b32 s43, v14
    s_add_u32 m0, s18, 12288
    s_add_u32 s19, s16, s76
    s_waitcnt vmcnt(15)
    buffer_load_dwordx4 v4, s[12:15], s19 offen nt lds
    s_add_u32 s47, s47, s26
    s_andn2_b32 s26, s47, s83
    s_and_b32 s47, s47, s83
    s_lshr_b32 s26, s26, 2
    s_add_u32 m0, s18, 13312
    s_add_u32 s19, s16, s77
    s_waitcnt vmcnt(15)
    buffer_load_dwordx4 v5, s[12:15], s19 offen nt lds
    s_add_u32 s25, s25, 5
    s_cmp_ge_u32 s37, 5
    s_cselect_b32 s45, s43, 0
    s_add_u32 m0, s18, 14336
    s_add_u32 s19, s16, s78
    s_waitcnt vmcnt(15)
    buffer_load_dwordx4 v6, s[12:15], s19 offen nt lds
    s_cmp_lg_u32 s45, s43
    s_cselect_b32 s26, s36, s26
    s_add_u32 m0, s18, 15360
    s_add_u32 s19, s16, s79
    s_waitcnt vmcnt(15)
    buffer_load_dwordx4 v7, s[12:15], s19 offen nt lds
    s_add_u32 s24, s22, 0
    v_mov_b32 v11, s24
    ds_write_b32 v10, v11
    s_cmp_gt_u32 s25, s23
    s_cbranch_scc0 L_wait
    s_bitcmp1_b32 s23, 8
    s_cbranch_scc1 L_drain
    s_cmp_lg_u32 s45, s44
    s_cbranch_scc1 L_switch
    s_cmp_eq_u32 s23, 128
    s_cselect_b64 s[12:13], s[20:21], s[12:13]
    s_mov_b32 s22, s23
    s_mov_b32 s16, s17
    s_mov_b32 s18, s27
    s_cmp_eq_u32 s26, 16
    s_cbranch_scc1 L_w16
    s_cmp_eq_u32 s26, 18
    s_cbranch_scc1 L_w18
    s_cmp_eq_u32 s26, 20
    s_cbranch_scc1 L_w20
    s_cmp_eq_u32 s26, 22
    s_cbranch_scc1 L_w22
    s_cmp_eq_u32 s26, 24
    s_cbranch_scc1 L_w24
    s_branch L_w20
L_w18:
    s_add_u32 m0, s18, 0
    s_mov_b32 s19, s16
    s_waitcnt vmcnt(17)
    buffer_load_dwordx4 v4, s[12:15], s19 offen nt lds
    s_add_u32 m0, s18, 1024
    s_add_u32 s19, s16, s65
    s_waitcnt vmcnt(17)
    buffer_load_dwordx4 v5, s[12:15], s19 offen nt lds
    s_add_u32 s24, s22, -1
    v_mov_b32 v11, s24
    ds_write_b32 v10, v11
    s_add_u32 m0, s18, 2048
    s_add_u32 s19, s16, s66
    s_waitcnt vmcnt(17)
    buffer_load_dwordx4 v6, s[12:15], s19 offen nt lds
    s_add_u32 m0, s18, 3072
    s_add_u32 s19, s16, s67
    s_waitcnt vmcnt(17)
    buffer_load_dwordx4 v7, s[12:15], s19 offen nt lds
    s_add_u32 s23, s22, 1
    s_bfe_u32 s37, s23, 0x50002
    s_bitcmp1_b32 s23, 7
    s_cselect_b32 s39, s41, 0
    s_cselect_b32 s36, 22, 20
    s_add_u32 m0, s18, 4096
    s_add_u32 s19, s16, s68
    s_waitcnt vmcnt(17)
    buffer_load_dwordx4 v4, s[12:15], s19 offen nt lds
    s_xor_b32 s37, s37, s39
    s_lshl_b32 s17, s37, 16
    s_xor_b32 s17, s17, s82
    s_add_u32 m0, s18, 5120
    s_add_u32 s19, s16, s69
    s_waitcnt vmcnt(17)
    buffer_load_dwordx4 v5, s[12:15], s19 offen nt lds
    s_bitcmp1_b32 s23, 0
    s_cselect_b32 s39, s80, 0
    s_xor_b32 s17, s17, s39
    s_add_u32 m0, s18, 6144
    s_add_u32 s19, s16, s70
    s_waitcnt vmcnt(17)
    buffer_load_dwordx4 v6, s[12:15], s19 offen nt lds
    s_bitcmp1_b32 s23, 1
    s_cselect_b32 s39, s81, 0
    s_xor_b32 s17, s17, s39
    s_add_u32 m0, s18, 7168
    s_add_u32 s19, s16, s71
    s_waitcnt vmcnt(17)
    buffer_load_dwordx4 v7, s[12:15], s19 offen nt lds
    s_add_u32 s27, s18, 16384
    s_cmp_eq_u32 s27, 81920
    s_cselect_b32 s27, 0, s27
    s_add_u32 m0, s18, 8192
    s_add_u32 s19, s16, s72
    s_waitcnt vmcnt(17)
    buffer_load_dwordx4 v4, s[12:15], s19 offen nt lds
    s_add_u32 m0, s18, 9216
    s_add_u32 s19, s16, s73
    s_waitcnt vmcnt(17)
    buffer_load_dwordx4 v5, s[12:15], s19 offen nt lds
    ds_read_b128 v[12:15], v10 offset:16
    s_add_u32 m0, s18, 10240
    s_add_u32 s19, s16, s74
    s_waitcnt vmcnt(17)
    buffer_load_dwordx4 v6, s[12:15], s19 offen nt lds
    s_add_u32 m0, s18, 11264
    s_add_u32 s19, s16, s75
    s_waitcnt vmcnt(17)
    buffer_load_dwordx4 v7, s[12:15], s19 offen nt lds
    s_waitcnt lgkmcnt(0)
    v_readfirstlane_b32 s25, v12
    v_readfirstlane_b32 s26, v13
    v_readfirstlane_b32 s43, v14
    s_add_u32 m0, s18, 12288
    s_add_u32 s19, s16, s76
    s_waitcnt vmcnt(17)
    buffer_load_dwordx4 v4, s[12:15], s19 offen nt lds
    s_add_u32 s47, s47, s26
    s_andn2_b32 s26, s47, s83
    s_and_b32 s47, s47, s83
    s_lshr_b32 s26, s26, 2
    s_add_u32 m0, s18, 13312
    s_add_u32 s19, s16, s77
    s_waitcnt vmcnt(17)
    buffer_load_dwordx4 v5, s[12:15], s19 offen nt lds
    s_add_u32 s25, s25, 5
    s_cmp_ge_u32 s37, 5
    s_cselect_b32 s45, s43, 0
    s_add_u32 m0, s18, 14336
    s_add_u32 s19, s16, s78
    s_waitcnt vmcnt(17)
    buffer_load_dwordx4 v6, s[12:15], s19 offen nt lds
    s_cmp_lg_u32 s45, s43
    s_cselect_b32 s26, s36, s26
    s_add_u32 m0, s18, 15360
    s_add_u32 s19, s16, s79
    s_waitcnt vmcnt(17)
    buffer_load_dwordx4 v7, s[12:15], s19 offen nt lds
    s_cmp_gt_u32 s25, s23
    s_cbranch_scc0 L_wait
    s_bitcmp1_b32 s23, 8
    s_cbranch_scc1 L_drain
    s_cmp_lg_u32 s45, s44
    s_cbranch_scc1 L_switch
    s_cmp_eq_u32 s23, 128
    s_cselect_b64 s[12:13], s[20:21], s[12:13]
    s_mov_b32 s22, s23
    s_mov_b32 s16, s17
    s_mov_b32 s18, s27
    s_cmp_eq_u32 s26, 18
    s_cbranch_scc1 L_w18
    s_cmp_eq_u32 s26, 16
    s_cbranch_scc1 L_w16
    s_cmp_eq_u32 s26, 20
    s_cbranch_scc1 L_w20
    s_cmp_eq_u32 s26, 22
    s_cbranch_scc1 L_w22
    s_cmp_eq_u32 s26, 24
    s_cbranch_scc1 L_w24
    s_branch L_w20
L_w22:
    s_add_u32 m0, s18, 0
    s_mov_b32 s19, s16
    s_waitcnt vmcnt(21)
    buffer_load_dwordx4 v4, s[12:15], s19 offen nt lds
    s_add_u32 m0, s18, 1024
    s_add_u32 s19, s16, s65
    s_waitcnt vmcnt(21)
    buffer_load_dwordx4 v5, s[12:15], s19 offen nt lds
    s_add_u32 m0, s18, 2048
    s_add_u32 s19, s16, s66
    s_waitcnt vmcnt(21)
    buffer_load_dwordx4 v6, s[12:15], s19 offen nt lds
    s_add_u32 m0, s18, 3072
    s_add_u32 s19, s16, s67
    s_waitcnt vmcnt(21)
    buffer_load_dwordx4 v7, s[12:15], s19 offen nt lds
    s_add_u32 s23, s22, 1
    s_bfe_u32 s37, s23, 0x50002
    s_bitcmp1_b32 s23, 7
    s_cselect_b32 s39, s41, 0
    s_cselect_b32 s36, 22, 20
    s_add_u32 m0, s18, 4096
    s_add_u32 s19, s16, s68
    s_waitcnt vmcnt(21)
    buffer_load_dwordx4 v4, s[12:15], s19 offen nt lds
    s_xor_b32 s37, s37, s39
    s_lshl_b32 s17, s37, 16
    s_xor_b32 s17, s17, s82
    s_add_u32 m0, s18, 5120
    s_add_u32 s19, s16, s69
    s_waitcnt vmcnt(21)
    buffer_load_dwordx4 v5, s[12:15], s19 offen nt lds
    s_add_u32 s24, s22, -1
    v_mov_b32 v11, s24
    ds_write_b32 v10, v11
    s_bitcmp1_b32 s23, 0
    s_cselect_b32 s39, s80, 0
    s_xor_b32 s17, s17, s39
    s_add_u32 m0, s18, 6144
    s_add_u32 s19, s16, s70
    s_waitcnt vmcnt(21)
    buffer_load_dwordx4 v6, s[12:15], s19 offen nt lds
    s_bitcmp1_b32 s23, 1
    s_cselect_b32 s39, s81, 0
    s_xor_b32 s17, s17, s39
    s_add_u32 m0, s18, 7168
    s_add_u32 s19, s16, s71
    s_waitcnt vmcnt(21)
    buffer_load_dwordx4 v7, s[12:15], s19 offen nt lds
    s_add_u32 s27, s18, 16384
    s_cmp_eq_u32 s27, 81920
    s_cselect_b32 s27, 0, s27
    s_add_u32 m0, s18, 8192
    s_add_u32 s19, s16, s72
    s_waitcnt vmcnt(21)
    buffer_load_dwordx4 v4, s[12:15], s19 offen nt lds
    s_add_u32 m0, s18, 9216
    s_add_u32 s19, s16, s73
    s_waitcnt vmcnt(21)
    buffer_load_dwordx4 v5, s[12:15], s19 offen nt lds
    ds_read_b128 v[12:15], v10 offset:16
    s_add_u32 m0, s18, 10240
    s_add_u32 s19, s16, s74
    s_waitcnt vmcnt(21)
    buffer_load_dwordx4 v6, s[12:15], s19 offen nt lds
    s_add_u32 m0, s18, 11264
    s_add_u32 s19, s16, s75
    s_waitcnt vmcnt(21)
    buffer_load_dwordx4 v7, s[12:15], s19 offen nt lds
    s_waitcnt lgkmcnt(0)
    v_readfirstlane_b32 s25, v12
    v_readfirstlane_b32 s26, v13
    v_readfirstlane_b32 s43, v14
    s_add_u32 m0, s18, 12288
    s_add_u32 s19, s16, s76
    s_waitcnt vmcnt(21)
    buffer_load_dwordx4 v4, s[12:15], s19 offen nt lds
    s_add_u32 s47, s47, s26
    s_andn2_b32 s26, s47, s83
    s_and_b32 s47, s47, s83
    s_lshr_b32 s26, s26, 2
    s_add_u32 m0, s18, 13312
    s_add_u32 s19, s16, s77
    s_waitcnt vmcnt(21)
    buffer_load_dwordx4 v5, s[12:15], s19 offen nt lds
    s_add_u32 s25, s25, 5
    s_cmp_ge_u32 s37, 5
    s_cselect_b32 s45, s43, 0
    s_add_u32 m0, s18, 14336
    s_add_u32 s19, s16, s78
    s_waitcnt vmcnt(21)
    buffer_load_dwordx4 v6, s[12:15], s19 offen nt lds
    s_cmp_lg_u32 s45, s43
    s_cselect_b32 s26, s36, s26
    s_add_u32 m0, s18, 15360
    s_add_u32 s19, s16, s79
    s_waitcnt vmcnt(21)
    buffer_load_dwordx4 v7, s[12:15], s19 offen nt lds
    s_cmp_gt_u32 s25, s23
    s_cbranch_scc0 L_wait
    s_bitcmp1_b32 s23, 8
    s_cbranch_scc1 L_drain
    s_cmp_lg_u32 s45, s44
    s_cbranch_scc1 L_switch
    s_cmp_eq_u32 s23, 128
    s_cselect_b64 s[12:13], s[20:21], s[12:13]
    s_mov_b32 s22, s23
    s_mov_b32 s16, s17
    s_mov_b32 s18, s27
    s_cmp_eq_u32 s26, 22
    s_cbranch_scc1 L_w22
    s_cmp_eq_u32 s26, 20
    s_cbranch_scc1 L_w20
    s_cmp_eq_u32 s26, 24
    s_cbranch_scc1 L_w24
    s_cmp_eq_u32 s26, 18
    s_cbranch_scc1 L_w18
    s_cmp_eq_u32 s26, 16
    s_cbranch_scc1 L_w16
    s_branch L_w20
L_w24:
    s_add_u32 m0, s18, 0
    s_mov_b32 s19, s16
    s_waitcnt vmcnt(23)
    buffer_load_dwordx4 v4, s[12:15], s19 offen nt lds
    s_add_u32 m0, s18, 1024
    s_add_u32 s19, s16, s65
    s_waitcnt vmcnt(23)
    buffer_load_dwordx4 v5, s[12:15], s19 offen nt lds
    s_add_u32 m0, s18, 2048
    s_add_u32 s19, s16, s66
    s_waitcnt vmcnt(23)
    buffer_load_dwordx4 v6, s[12:15], s19 offen nt lds
    s_add_u32 m0, s18, 3072
    s_add_u32 s19, s16, s67
    s_waitcnt vmcnt(23)
    buffer_load_dwordx4 v7, s[12:15], s19 offen nt lds
    s_add_u32 s23, s22, 1
    s_bfe_u32 s37, s23, 0x50002
    s_bitcmp1_b32 s23, 7
    s_cselect_b32 s39, s41, 0
    s_cselect_b32 s36, 22, 20
    s_add_u32 m0, s18, 4096
    s_add_u32 s19, s16, s68
    s_waitcnt vmcnt(23)
    buffer_load_dwordx4 v4, s[12:15], s19 offen nt lds
    s_xor_b32 s37, s37, s39
    s_lshl_b32 s17, s37, 16
    s_xor_b32 s17, s17, s82
    s_add_u32 m0, s18, 5120
    s_add_u32 s19, s16, s69
    s_waitcnt vmcnt(23)
    buffer_load_dwordx4 v5, s[12:15], s19 offen nt lds
    s_bitcmp1_b32 s23, 0
    s_cselect_b32 s39, s80, 0
    s_xor_b32 s17, s17, s39
    s_add_u32 m0, s18, 6144
    s_add_u32 s19, s16, s70
    s_waitcnt vmcnt(23)
    buffer_load_dwordx4 v6, s[12:15], s19 offen nt lds
    s_bitcmp1_b32 s23, 1
    s_cselect_b32 s39, s81, 0
    s_xor_b32 s17, s17, s39
    s_add_u32 m0, s18, 7168
    s_add_u32 s19, s16, s71
    s_waitcnt vmcnt(23)
    buffer_load_dwordx4 v7, s[12:15], s19 offen nt lds
    s_add_u32 s24, s22, -1
    v_mov_b32 v11, s24
    ds_write_b32 v10, v11
    s_add_u32 s27, s18, 16384
    s_cmp_eq_u32 s27, 81920
    s_cselect_b32 s27, 0, s27
    s_add_u32 m0, s18, 8192
    s_add_u32 s19, s16, s72
    s_waitcnt vmcnt(23)
    buffer_load_dwordx4 v4, s[12:15], s19 offen nt lds
    s_add_u32 m0, s18, 9216
    s_add_u32 s19, s16, s73
    s_waitcnt vmcnt(23)
    buffer_load_dwordx4 v5, s[12:15], s19 offen nt lds
    ds_read_b128 v[12:15], v10 offset:16
    s_add_u32 m0, s18, 10240
    s_add_u32 s19, s16, s74
    s_waitcnt vmcnt(23)
    buffer_load_dwordx4 v6, s[12:15], s19 offen nt lds
    s_add_u32 m0, s18, 11264
    s_add_u32 s19, s16, s75
    s_waitcnt vmcnt(23)
    buffer_load_dwordx4 v7, s[12:15], s19 offen nt lds
    s_waitcnt lgkmcnt(0)
    v_readfirstlane_b32 s25, v12
    v_readfirstlane_b32 s26, v13
    v_readfirstlane_b32 s43, v14
    s_add_u32 m0, s18, 12288
    s_add_u32 s19, s16, s76
    s_waitcnt vmcnt(23)
    buffer_load_dwordx4 v4, s[12:15], s19 offen nt lds
    s_add_u32 s47, s47, s26
    s_andn2_b32 s26, s47, s83
    s_and_b32 s47, s47, s83
    s_lshr_b32 s26, s26, 2
    s_add_u32 m0, s18, 13312
    s_add_u32 s19, s16, s77
    s_waitcnt vmcnt(23)
    buffer_load_dwordx4 v5, s[12:15], s19 offen nt lds
    s_add_u32 s25, s25, 5
    s_cmp_ge_u32 s37, 5
    s_cselect_b32 s45, s43, 0
    s_add_u32 m0, s18, 14336
    s_add_u32 s19, s16, s78
    s_waitcnt vmcnt(23)
    buffer_load_dwordx4 v6, s[12:15], s19 offen nt lds
    s_cmp_lg_u32 s45, s43
    s_cselect_b32 s26, s36, s26
    s_add_u32 m0, s18, 15360
    s_add_u32 s19, s16, s79
    s_waitcnt vmcnt(23)
    buffer_load_dwordx4 v7, s[12:15], s19 offen nt lds
    s_cmp_gt_u32 s25, s23
    s_cbranch_scc0 L_wait
    s_bitcmp1_b32 s23, 8
    s_cbranch_scc1 L_drain
    s_cmp_lg_u32 s45, s44
    s_cbranch_scc1 L_switch
    s_cmp_eq_u32 s23, 128
    s_cselect_b64 s[12:13], s[20:21], s[12:13]
    s_mov_b32 s22, s23
    s_mov_b32 s16, s17
    s_mov_b32 s18, s27
    s_cmp_eq_u32 s26, 24
    s_cbranch_scc1 L_w24
    s_cmp_eq_u32 s26, 22
    s_cbranch_scc1 L_w22
    s_cmp_eq_u32 s26, 20
    s_cbranch_scc1 L_w20
    s_cmp_eq_u32 s26, 18
    s_cbranch_scc1 L_w18
    s_cmp_eq_u32 s26, 16
    s_cbranch_scc1 L_w16
    s_branch L_w20
L_switch:
    s_cmp_eq_u32 s45, 2
    s_cbranch_scc1 L_wait
    s_cmp_eq_u32 s45, 0
    s_cbranch_scc1 L_tomix
    v_readfirstlane_b32 s46, v15
    s_lshr_b32 s39, s23, 7
    s_and_b32 s39, s39, s46
    s_lshl_b32 s39, s39, 13
    s_xor_b32 s46, s46, s39
    s_and_b32 s46, s46, 0x2000
    s_mov_b32 s65, 0x8000
    s_mov_b32 s66, 0x400
    s_mov_b32 s67, 0x8400
    s_mov_b32 s68, 0x800
    s_mov_b32 s69, 0x8800
    s_mov_b32 s70, 0xc00
    s_mov_b32 s71, 0x8c00
    s_mov_b32 s72, 0x1000
    s_mov_b32 s73, 0x9000
    s_mov_b32 s74, 0x1400
    s_mov_b32 s75, 0x9400
    s_mov_b32 s76, 0x1800
    s_mov_b32 s77, 0x9800
    s_mov_b32 s78, 0x1c00
    s_mov_b32 s79, 0x9c00
    s_mov_b32 s80, 0x4000
    s_mov_b32 s81, 0x202000
    s_mov_b32 s82, s46
    s_mov_b32 s83, 7
    s_mov_b32 s44, 1
    s_branch L_switched
L_tomix:
    s_mov_b32 s65, 0x2000
    s_mov_b32 s66, 0x8000
    s_mov_b32 s67, 0xa000
    s_mov_b32 s68, 0x400
    s_mov_b32 s69, 0x2400
    s_mov_b32 s70, 0x8400
    s_mov_b32 s71, 0xa400
    s_mov_b32 s72, 0x800
    s_mov_b32 s73, 0x2800
    s_mov_b32 s74, 0x8800
    s_mov_b32 s75, 0xa800
    s_mov_b32 s76, 0xc00
    s_mov_b32 s77, 0x2c00
    s_mov_b32 s78, 0x8c00
    s_mov_b32 s79, 0xac00
    s_mov_b32 s80, 0x1000
    s_mov_b32 s81, 0x4000
    s_lshl_b32 s82, s34, 21
    s_mov_b32 s83, 15
    s_mov_b32 s44, 0
L_switched:
    s_lshl_b32 s17, s37, 16
    s_xor_b32 s17, s17, s82
    s_branch L_next2
L_wait:
    s_bitcmp1_b32 s23, 8
    s_cbranch_scc1 L_drain
    s_sub_u32 s40, s40, 1
    s_cbranch_scc1 L_exit
    ds_read_b128 v[12:15], v10 offset:16
    s_waitcnt lgkmcnt(0)
    v_readfirstlane_b32 s25, v12
    v_readfirstlane_b32 s26, v13
    v_readfirstlane_b32 s43, v14
    s_add_u32 s47, s47, s26
    s_andn2_b32 s26, s47, s83
    s_and_b32 s47, s47, s83
    s_lshr_b32 s26, s26, 2
    s_add_u32 s25, s25, 5
    s_cmp_ge_u32 s37, 5
    s_cselect_b32 s45, s43, 0
    s_cmp_lg_u32 s45, s43
    s_cselect_b32 s26, s36, s26
    s_cmp_gt_u32 s25, s23
    s_cbranch_scc1 L_next
    s_branch L_wait
L_drain:
    s_waitcnt vmcnt(16)
    s_add_u32 s24, s22, 0
    v_mov_b32 v11, s24
    ds_write_b32 v10, v11
    s_waitcnt vmcnt(0)
    s_add_u32 s24, s22, 1
    v_mov_b32 v11, s24
    ds_write_b32 v10, v11
    s_endpgm
L_consumer:
    v_and_b32 v3, 3, v2
    v_lshrrev_b32 v4, 4, v2
    s_lshl_b32 s35, s33, 12
    v_lshl_add_u32 v248, v2, 4, s35
    s_lshl_b32 s35, s33, 8
    s_add_u32 s35, s35, 0x80000
    v_lshl_add_u32 v251, v3, 3, s35
    v_mov_b32 v246, 149504
    v_lshlrev_b32 v5, 1, v3
    v_xor_b32 v5, v5, v4
    v_lshlrev_b32 v5, 4, v5
    v_lshl_add_u32 v5, v3, 9, v5
    v_add_u32 v5, 147456, v5
    v_xor_b32 v6, 64, v5
    v_and_b32 v0, 15, v2
    v_and_b32 v243, 7, v2
    v_lshlrev_b32 v243, 1, v243
    v_xor_b32 v1, v4, v243
    v_lshlrev_b32 v1, 4, v1
    v_lshl_add_u32 v216, v0, 9, v1
    v_xor_b32 v217, 64, v216
    v_xor_b32 v218, 128, v216
    v_xor_b32 v219, 192, v216
    v_lshrrev_b32 v0, 2, v2
    v_and_b32 v1, 7, v0
    v_lshlrev_b32 v0, 9, v0
    v_lshl_add_u32 v0, v3, 3, v0
    v_lshl_add_u32 v224, v1, 5, v0
    v_xor_b32 v225, 32, v224
    v_xor_b32 v226, 64, v224
    v_xor_b32 v227, 96, v224
    v_xor_b32 v228, 128, v224
    v_xor_b32 v229, 160, v224
    v_xor_b32 v230, 192, v224
    v_xor_b32 v231, 224, v224
    v_bfe_u32 v0, v2, 2, 2
    v_cmp_eq_u32 vcc, 0, v0
    s_nop 1
    v_cndmask_b32 v212, 0, -1, vcc
    v_cmp_eq_u32 vcc, 1, v0
    s_nop 1
    v_cndmask_b32 v213, 0, -1, vcc
    v_cmp_eq_u32 vcc, 2, v0
    s_nop 1
    v_cndmask_b32 v214, 0, -1, vcc
    v_cmp_eq_u32 vcc, 3, v0
    s_nop 1
    v_cndmask_b32 v215, 0, -1, vcc
    s_lshl_b32 s41, s33, 11
    v_lshlrev_b32 v249, 9, v3
    v_lshl_add_u32 v249, v0, 5, v249
    v_lshl_add_u32 v249, v4, 3, v249
    v_add_u32 v249, s41, v249
    v_lshl_add_u32 v250, v4, 2, v3
    v_lshlrev_b32 v250, 4, v250
    v_add_u32 v250, 81920, v250
    v_mov_b32 v168, 0
    v_mov_b32 v169, 0
    v_mov_b32 v170, 0
    v_mov_b32 v171, 0
    v_mov_b32 v172, 0
    v_mov_b32 v173, 0
    v_mov_b32 v174, 0
    v_mov_b32 v175, 0
    v_mov_b32 v176, 0
    v_mov_b32 v177, 0
    v_mov_b32 v178, 0
    v_mov_b32 v179, 0
    v_mov_b32 v180, 0
    v_mov_b32 v181, 0
    v_mov_b32 v182, 0
    v_mov_b32 v183, 0
    v_mov_b32 v240, 0xff800000
    v_mov_b32 v241, 0
    s_mov_b32 s44, 0x3db8aa3b
    s_mov_b32 s46, 0x000f000f
    s_mov_b32 s47, 0x000f000f
    s_mov_b32 s22, 0
    s_mov_b32 s23, 0
    s_mov_b32 s18, 0
    s_mov_b32 s40, 4194304
    s_cmp_gt_u32 s23, s22
    s_cbranch_scc1 L_goq
L_pollq:
    ds_read_b32 v1, v246
    s_sub_u32 s40, s40, 1
    s_cbranch_scc1 L_exit
    s_waitcnt lgkmcnt(0)
    v_readfirstlane_b32 s23, v1
    s_cmp_gt_u32 s23, s22
    s_cbranch_scc0 L_pollq
L_goq:
    ds_read_b128 v[8:11], v5 offset:0
    ds_read_b128 v[12:15], v6 offset:0
    ds_read_b128 v[16:19], v5 offset:128
    ds_read_b128 v[20:23], v6 offset:128
    ds_read_b128 v[24:27], v5 offset:256
    ds_read_b128 v[28:31], v6 offset:256
    ds_read_b128 v[32:35], v5 offset:384
    ds_read_b128 v[36:39], v6 offset:384
    s_waitcnt lgkmcnt(0)
L_krnd:
    v_add_u32 v220, s18, v216
    v_add_u32 v221, s18, v217
    v_add_u32 v222, s18, v218
    v_add_u32 v223, s18, v219
    s_add_u32 s18, s18, 16384
    s_cmp_eq_u32 s18, 81920
    s_cselect_b32 s18, 0, s18
    s_cmp_gt_u32 s23, s22
    s_cbranch_scc1 L_gok
L_pollk:
    ds_read_b32 v1, v246
    s_sub_u32 s40, s40, 1
    s_cbranch_scc1 L_exit
    s_waitcnt lgkmcnt(0)
    v_readfirstlane_b32 s23, v1
    s_cmp_gt_u32 s23, s22
    s_cbranch_scc0 L_pollk
L_gok:
    ds_read_b128 v[40:43], v220 offset:0
    ds_read_b128 v[44:47], v220 offset:8192
    ds_read_b128 v[48:51], v221 offset:0
    ds_read_b128 v[52:55], v221 offset:8192
    ds_read_b128 v[56:59], v222 offset:0
    ds_read_b128 v[60:63], v222 offset:8192
    ds_read_b128 v[64:67], v223 offset:0
    ds_read_b128 v[68:71], v223 offset:8192
    ds_read_b128 v[72:75], v220 offset:256
    ds_read_b128 v[76:79], v220 offset:8448
    ds_read_b128 v[80:83], v221 offset:256
    ds_read_b128 v[84:87], v221 offset:8448
    s_waitcnt lgkmcnt(11)
    v_mfma_f32_16x16x32_bf16 v[184:187], v[40:43], v[8:11], 0
    ds_read_b128 v[88:91], v222 offset:256
    s_waitcnt lgkmcnt(11)
    v_mfma_f32_16x16x32_bf16 v[188:191], v[44:47], v[8:11], 0
    ds_read_b128 v[92:95], v222 offset:8448
    s_waitcnt lgkmcnt(11)
    v_mfma_f32_16x16x32_bf16 v[184:187], v[48:51], v[12:15], v[184:187]
    ds_read_b128 v[96:99], v223 offset:256
    s_waitcnt lgkmcnt(11)
    v_mfma_f32_16x16x32_bf16 v[188:191], v[52:55], v[12:15], v[188:191]
    ds_read_b128 v[100:103], v223 offset:8448
    s_waitcnt lgkmcnt(11)
    v_mfma_f32_16x16x32_bf16 v[184:187], v[56:59], v[16:19], v[184:187]
    s_waitcnt lgkmcnt(10)
    v_mfma_f32_16x16x32_bf16 v[188:191], v[60:63], v[16:19], v[188:191]
    s_waitcnt lgkmcnt(9)
    v_mfma_f32_16x16x32_bf16 v[184:187], v[64:67], v[20:23], v[184:187]
    s_waitcnt lgkmcnt(8)
    v_mfma_f32_16x16x32_bf16 v[188:191], v[68:71], v[20:23], v[188:191]
    s_waitcnt lgkmcnt(7)
    v_mfma_f32_16x16x32_bf16 v[184:187], v[72:75], v[24:27], v[184:187]
    s_waitcnt lgkmcnt(6)
    v_mfma_f32_16x16x32_bf16 v[188:191], v[76:79], v[24:27], v[188:191]
    s_waitcnt lgkmcnt(5)
    v_mfma_f32_16x16x32_bf16 v[184:187], v[80:83], v[28:31], v[184:187]
    s_waitcnt lgkmcnt(4)
    v_mfma_f32_16x16x32_bf16 v[188:191], v[84:87], v[28:31], v[188:191]
    s_waitcnt lgkmcnt(3)
    v_mfma_f32_16x16x32_bf16 v[184:187], v[88:91], v[32:35], v[184:187]
    s_waitcnt lgkmcnt(2)
    v_mfma_f32_16x16x32_bf16 v[188:191], v[92:95], v[32:35], v[188:191]
    s_waitcnt lgkmcnt(1)
    v_mfma_f32_16x16x32_bf16 v[184:187], v[96:99], v[36:39], v[184:187]
    s_waitcnt lgkmcnt(0)
    v_mfma_f32_16x16x32_bf16 v[188:191], v[100:103], v[36:39], v[188:191]
    s_add_u32 s22, s22, 1
    v_mov_b32 v7, s22
    ds_write_b32 v246, v7 offset:16
    s_nop 4
    s_mov_b64 exec, s[46:47]
    ds_write_b128 v250, v[184:187]
    ds_write_b128 v250, v[188:191] offset:256
    s_mov_b64 exec, -1
    v_max3_f32 v240, v240, v184, v185
    v_max3_f32 v240, v240, v186, v187
    v_max3_f32 v240, v240, v188, v189
    v_max3_f32 v240, v240, v190, v191
    v_add_u32 v250, 512, v250
    s_cmp_lt_u32 s22, 128
    s_cbranch_scc1 L_krnd
    ds_read_b32 v1, v246 offset:28
    v_lshl_add_u32 v0, v3, 2, v246
    v_mov_b32 v244, v240
    v_subrev_u32 v247, 0x10000, v250
    s_cmp_eq_u32 s32, 1
    v_permlane16_swap_b32 v240, v244
    s_cselect_b32 s51, 252, -1
    s_mov_b32 s45, 0
    v_max_f32 v240, v240, v244
    v_mov_b32 v244, v240
    s_nop 1
    v_permlane32_swap_b32 v240, v244
    s_nop 1
    v_max_f32 v240, v240, v244
    v_mul_f32 v242, s44, v240
    s_bfe_u32 s41, s33, 0x10006
    s_mul_i32 s41, s41, 32768
    v_add_u32 v250, s41, v247
    s_xor_b32 s41, s41, 0x10000
    ds_write_b32 v0, v240 offset:64
    s_waitcnt lgkmcnt(0)
    v_readfirstlane_b32 s48, v1
    s_and_b32 s48, s48, 1
    s_cselect_b32 s43, 148, s51
L_vrnd:
    s_cmp_ge_u32 s22, s43
    s_cbranch_scc1 L_vevent
L_peekret:
    ds_read_b128 v[184:187], v250
    ds_read_b128 v[188:191], v250 offset:256
    v_add_u32 v232, s18, v224
    v_add_u32 v233, s18, v225
    v_add_u32 v234, s18, v226
    v_add_u32 v235, s18, v227
    v_add_u32 v236, s18, v228
    v_add_u32 v237, s18, v229
    v_add_u32 v238, s18, v230
    v_add_u32 v239, s18, v231
    s_add_u32 s42, s22, 1
    s_lshl_b32 s42, s42, 9
    s_xor_b32 s42, s42, s41
    v_add_u32 v250, s42, v247
    s_add_u32 s18, s18, 16384
    s_cmp_eq_u32 s18, 81920
    s_cselect_b32 s18, 0, s18
    s_waitcnt lgkmcnt(0)
    v_fma_f32 v184, v184, s44, -v242
    v_fma_f32 v185, v185, s44, -v242
    v_fma_f32 v186, v186, s44, -v242
    v_fma_f32 v187, v187, s44, -v242
    v_fma_f32 v188, v188, s44, -v242
    v_fma_f32 v189, v189, s44, -v242
    v_fma_f32 v190, v190, s44, -v242
    v_fma_f32 v191, v191, s44, -v242
    v_exp_f32 v184, v184
    v_exp_f32 v185, v185
    v_exp_f32 v186, v186
    v_exp_f32 v187, v187
    v_exp_f32 v188, v188
    v_exp_f32 v189, v189
    v_exp_f32 v190, v190
    v_exp_f32 v191, v191
    s_nop 0
    v_cvt_pk_bf16_f32 v192, v184, v185
    v_cvt_pk_bf16_f32 v193, v186, v187
    v_cvt_pk_bf16_f32 v194, v188, v189
    v_cvt_pk_bf16_f32 v195, v190, v191
    v_and_b32 v196, v212, v192
    v_and_b32 v197, v212, v193
    v_and_b32 v198, v212, v194
    v_and_b32 v199, v212, v195
    v_and_b32 v200, v213, v192
    v_and_b32 v201, v213, v193
    v_and_b32 v202, v213, v194
    v_and_b32 v203, v213, v195
    v_and_b32 v204, v214, v192
    v_and_b32 v205, v214, v193
    v_and_b32 v206, v214, v194
    v_and_b32 v207, v214, v195
    v_and_b32 v208, v215, v192
    v_and_b32 v209, v215, v193
    v_and_b32 v210, v215, v194
    v_and_b32 v211, v215, v195
    v_add_f32 v243, v184, v185
    v_add_f32 v244, v186, v187
    v_add_f32 v245, v188, v189
    v_add_f32 v243, v243, v244
    v_add_f32 v244, v190, v191
    v_add_f32 v245, v245, v244
    v_add_f32 v243, v243, v245
    v_add_f32 v241, v241, v243
    s_cmp_eq_u32 s22, 255
    s_cbranch_scc1 L_last
L_lastret:
    s_cmp_gt_u32 s23, s22
    s_cbranch_scc1 L_gov
L_pollv:
    ds_read_b32 v1, v246
    s_sub_u32 s40, s40, 1
    s_cbranch_scc1 L_exit
    s_waitcnt lgkmcnt(0)
    v_readfirstlane_b32 s23, v1
    s_cmp_gt_u32 s23, s22
    s_cbranch_scc0 L_pollv
L_gov:
    ds_read_b64_tr_b16 v[104:105], v232 offset:0
    ds_read_b64_tr_b16 v[106:107], v232 offset:8192
    ds_read_b64_tr_b16 v[108:109], v236 offset:0
    ds_read_b64_tr_b16 v[110:111], v236 offset:8192
    ds_read_b64_tr_b16 v[112:113], v232 offset:256
    ds_read_b64_tr_b16 v[114:115], v232 offset:8448
    ds_read_b64_tr_b16 v[116:117], v236 offset:256
    ds_read_b64_tr_b16 v[118:119], v236 offset:8448
    ds_read_b64_tr_b16 v[120:121], v233 offset:0
    ds_read_b64_tr_b16 v[122:123], v233 offset:8192
    ds_read_b64_tr_b16 v[124:125], v237 offset:0
    ds_read_b64_tr_b16 v[126:127], v237 offset:8192
    ds_read_b64_tr_b16 v[128:129], v233 offset:256
    ds_read_b64_tr_b16 v[130:131], v233 offset:8448
    s_waitcnt lgkmcnt(12)
    v_mfma_f32_16x16x32_bf16 v[168:171], v[104:107], v[196:199], v[168:171]
    ds_read_b64_tr_b16 v[132:133], v237 offset:256
    ds_read_b64_tr_b16 v[134:135], v237 offset:8448
    s_waitcnt lgkmcnt(12)
    v_mfma_f32_16x16x32_bf16 v[172:175], v[108:111], v[196:199], v[172:175]
    ds_read_b64_tr_b16 v[136:137], v234 offset:0
    ds_read_b64_tr_b16 v[138:139], v234 offset:8192
    s_waitcnt lgkmcnt(12)
    v_mfma_f32_16x16x32_bf16 v[176:179], v[112:115], v[196:199], v[176:179]
    ds_read_b64_tr_b16 v[140:141], v238 offset:0
    ds_read_b64_tr_b16 v[142:143], v238 offset:8192
    s_waitcnt lgkmcnt(12)
    v_mfma_f32_16x16x32_bf16 v[180:183], v[116:119], v[196:199], v[180:183]
    ds_read_b64_tr_b16 v[144:145], v234 offset:256
    ds_read_b64_tr_b16 v[146:147], v234 offset:8448
    s_waitcnt lgkmcnt(12)
    v_mfma_f32_16x16x32_bf16 v[168:171], v[120:123], v[200:203], v[168:171]
    ds_read_b64_tr_b16 v[148:149], v238 offset:256
    ds_read_b64_tr_b16 v[150:151], v238 offset:8448
    s_waitcnt lgkmcnt(12)
    v_mfma_f32_16x16x32_bf16 v[172:175], v[124:127], v[200:203], v[172:175]
    ds_read_b64_tr_b16 v[152:153], v235 offset:0
    ds_read_b64_tr_b16 v[154:155], v235 offset:8192
    s_waitcnt lgkmcnt(12)
    v_mfma_f32_16x16x32_bf16 v[176:179], v[128:131], v[200:203], v[176:179]
    ds_read_b64_tr_b16 v[156:157], v239 offset:0
    ds_read_b64_tr_b16 v[158:159], v239 offset:8192
    s_waitcnt lgkmcnt(12)
    v_mfma_f32_16x16x32_bf16 v[180:183], v[132:135], v[200:203], v[180:183]
    ds_read_b64_tr_b16 v[160:161], v235 offset:256
    ds_read_b64_tr_b16 v[162:163], v235 offset:8448
    s_waitcnt lgkmcnt(12)
    v_mfma_f32_16x16x32_bf16 v[168:171], v[136:139], v[204:207], v[168:171]
    ds_read_b64_tr_b16 v[164:165], v239 offset:256
    ds_read_b64_tr_b16 v[166:167], v239 offset:8448
    s_waitcnt lgkmcnt(12)
    v_mfma_f32_16x16x32_bf16 v[172:175], v[140:143], v[204:207], v[172:175]
    s_waitcnt lgkmcnt(10)
    v_mfma_f32_16x16x32_bf16 v[176:179], v[144:147], v[204:207], v[176:179]
    s_waitcnt lgkmcnt(8)
    v_mfma_f32_16x16x32_bf16 v[180:183], v[148:151], v[204:207], v[180:183]
    s_waitcnt lgkmcnt(6)
    v_mfma_f32_16x16x32_bf16 v[168:171], v[152:155], v[208:211], v[168:171]
    s_waitcnt lgkmcnt(4)
    v_mfma_f32_16x16x32_bf16 v[172:175], v[156:159], v[208:211], v[172:175]
    s_waitcnt lgkmcnt(2)
    v_mfma_f32_16x16x32_bf16 v[176:179], v[160:163], v[208:211], v[176:179]
    s_waitcnt lgkmcnt(0)
    v_mfma_f32_16x16x32_bf16 v[180:183], v[164:167], v[208:211], v[180:183]
    s_add_u32 s22, s22, 1
    v_mov_b32 v7, s22
    ds_write_b32 v246, v7 offset:16
    s_cmp_lt_u32 s22, 256
    s_cbranch_scc1 L_vrnd
    s_cmp_eq_u32 s45, 2
    s_cbranch_scc1 L_merge2
    s_cmp_eq_u32 s32, 1
    s_cbranch_scc1 L_second
    global_store_dwordx4 v248, v[168:171], s[30:31] offset:0 sc1
    global_store_dwordx4 v248, v[172:175], s[30:31] offset:1024 sc1
    global_store_dwordx4 v248, v[176:179], s[30:31] offset:2048 sc1
    global_store_dwordx4 v248, v[180:183], s[30:31] offset:3072 sc1
    v_min_u32 v240, -2, v242
    v_min_u32 v241, -2, v241
    s_mov_b64 exec, 15
    s_waitcnt vmcnt(0)
    global_store_dwordx2 v251, v[240:241], s[30:31] sc1
    s_endpgm
L_second:
    s_mov_b32 s40, 524288
    s_cmp_eq_u32 s45, 1
    s_cbranch_scc1 L_mlchk
L_ml:
    global_load_dwordx2 v[56:57], v251, s[30:31] sc1
L_mlchk:
    s_waitcnt vmcnt(0)
    v_max_u32 v1, v56, v57
    v_cmp_eq_u32 vcc, -1, v1
    s_cbranch_vccz L_mlok
    s_sub_u32 s40, s40, 1
    s_cbranch_scc0 L_ml
    s_endpgm
L_mlok:
    global_load_dwordx4 v[40:43], v248, s[30:31] offset:0 sc1
    global_load_dwordx4 v[44:47], v248, s[30:31] offset:1024 sc1
    global_load_dwordx4 v[48:51], v248, s[30:31] offset:2048 sc1
    global_load_dwordx4 v[52:55], v248, s[30:31] offset:3072 sc1
    v_max_f32 v243, v242, v56
    v_sub_f32 v244, v242, v243
    v_sub_f32 v245, v56, v243
    v_exp_f32 v244, v244
    v_exp_f32 v245, v245
    s_nop 0
    v_mul_f32 v241, v241, v244
    v_fmac_f32 v241, v57, v245
    v_rcp_f32 v241, v241
    s_nop 0
    v_mul_f32 v244, v244, v241
    v_mul_f32 v245, v245, v241
L_merge2:
    s_waitcnt vmcnt(0)
    v_mul_f32 v40, v40, v245
    v_mul_f32 v41, v41, v245
    v_mul_f32 v42, v42, v245
    v_mul_f32 v43, v43, v245
    v_fmac_f32 v40, v168, v244
    v_fmac_f32 v41, v169, v244
    v_fmac_f32 v42, v170, v244
    v_fmac_f32 v43, v171, v244
    v_cvt_pk_bf16_f32 v104, v40, v41
    v_cvt_pk_bf16_f32 v105, v42, v43
    global_store_dwordx2 v249, v[104:105], s[10:11] offset:0 sc0 sc1
    v_mul_f32 v44, v44, v245
    v_mul_f32 v45, v45, v245
    v_mul_f32 v46, v46, v245
    v_mul_f32 v47, v47, v245
    v_fmac_f32 v44, v172, v244
    v_fmac_f32 v45, v173, v244
    v_fmac_f32 v46, v174, v244
    v_fmac_f32 v47, v175, v244
    v_cvt_pk_bf16_f32 v106, v44, v45
    v_cvt_pk_bf16_f32 v107, v46, v47
    global_store_dwordx2 v249, v[106:107], s[10:11] offset:128 sc0 sc1
    v_mul_f32 v48, v48, v245
    v_mul_f32 v49, v49, v245
    v_mul_f32 v50, v50, v245
    v_mul_f32 v51, v51, v245
    v_fmac_f32 v48, v176, v244
    v_fmac_f32 v49, v177, v244
    v_fmac_f32 v50, v178, v244
    v_fmac_f32 v51, v179, v244
    v_cvt_pk_bf16_f32 v108, v48, v49
    v_cvt_pk_bf16_f32 v109, v50, v51
    global_store_dwordx2 v249, v[108:109], s[10:11] offset:256 sc0 sc1
    v_mul_f32 v52, v52, v245
    v_mul_f32 v53, v53, v245
    v_mul_f32 v54, v54, v245
    v_mul_f32 v55, v55, v245
    v_fmac_f32 v52, v180, v244
    v_fmac_f32 v53, v181, v244
    v_fmac_f32 v54, v182, v244
    v_fmac_f32 v55, v183, v244
    v_cvt_pk_bf16_f32 v110, v52, v53
    v_cvt_pk_bf16_f32 v111, v54, v55
    global_store_dwordx2 v249, v[110:111], s[10:11] offset:384 sc0 sc1
L_fin:
L_exit:
    s_endpgm
L_vevent:
    s_cmp_eq_u32 s48, 0
    s_cbranch_scc1 L_peek
L_recv:
    ds_read_b32 v1, v246 offset:52
    ds_read_b32 v243, v0 offset:32
    s_sub_u32 s40, s40, 1
    s_cbranch_scc1 L_exit
    s_waitcnt lgkmcnt(0)
    v_readfirstlane_b32 s38, v1
    s_cmp_eq_u32 s38, 0
    s_cbranch_scc1 L_recv
    v_mul_f32 v243, s44, v243
    v_max_f32 v243, v243, v242
    v_sub_f32 v244, v242, v243
    v_exp_f32 v244, v244
    v_mov_b32 v242, v243
    v_mul_f32 v241, v241, v244
    v_mul_f32 v168, v168, v244
    v_mul_f32 v169, v169, v244
    v_mul_f32 v170, v170, v244
    v_mul_f32 v171, v171, v244
    v_mul_f32 v172, v172, v244
    v_mul_f32 v173, v173, v244
    v_mul_f32 v174, v174, v244
    v_mul_f32 v175, v175, v244
    v_mul_f32 v176, v176, v244
    v_mul_f32 v177, v177, v244
    v_mul_f32 v178, v178, v244
    v_mul_f32 v179, v179, v244
    v_mul_f32 v180, v180, v244
    v_mul_f32 v181, v181, v244
    v_mul_f32 v182, v182, v244
    v_mul_f32 v183, v183, v244
    s_mov_b32 s48, 0
    s_mov_b32 s43, s51
    s_branch L_peekret
L_peek:
    s_cmp_eq_u32 s45, 0
    s_cbranch_scc1 L_peekld
    s_waitcnt vmcnt(0)
    v_max_u32 v1, v56, v57
    v_cmp_eq_u32 vcc, -1, v1
    s_cbranch_vccz L_peekok
L_peekld:
    global_load_dwordx2 v[56:57], v251, s[30:31] sc1
    s_mov_b32 s45, 1
    s_branch L_peekret
L_peekok:
    global_load_dwordx4 v[40:43], v248, s[30:31] offset:0 sc1
    global_load_dwordx4 v[44:47], v248, s[30:31] offset:1024 sc1
    global_load_dwordx4 v[48:51], v248, s[30:31] offset:2048 sc1
    global_load_dwordx4 v[52:55], v248, s[30:31] offset:3072 sc1
    s_mov_b32 s43, -1
    s_mov_b32 s45, 2
    s_branch L_peekret
L_last:
    v_mov_b32 v244, v241
    s_nop 1
    v_permlane16_swap_b32 v241, v244
    s_nop 1
    v_add_f32 v241, v241, v244
    v_mov_b32 v244, v241
    s_nop 1
    v_permlane32_swap_b32 v241, v244
    s_nop 1
    v_add_f32 v241, v241, v244
    s_cmp_lg_u32 s45, 2
    s_cbranch_scc1 L_lastret
    v_max_f32 v243, v242, v56
    v_sub_f32 v244, v242, v243
    v_sub_f32 v245, v56, v243
    v_exp_f32 v244, v244
    v_exp_f32 v245, v245
    s_nop 0
    v_mul_f32 v241, v241, v244
    v_fmac_f32 v241, v57, v245
    v_rcp_f32 v241, v241
    s_nop 0
    v_mul_f32 v244, v244, v241
    v_mul_f32 v245, v245, v241
    s_branch L_lastret
L_helper:
    v_mov_b32 v0, 0
    s_mov_b32 s40, 4194304
    s_waitcnt lgkmcnt(0)
    s_cmp_eq_u32 s2, 8
    s_cbranch_scc1 L_clear
    s_cmp_ge_u32 s2, 8
    s_cbranch_scc1 L_look
    s_getreg_b32 s19, hwreg(HW_REG_XCC_ID, 0, 3)
    s_lshl_b32 s20, s19, 24
    s_cmp_eq_u32 s2, 0
    s_cselect_b32 s20, s20, 0
    s_add_u32 s20, s20, 1
    s_lshr_b32 s19, s19, 2
    s_lshl_b32 s14, s2, 26
    s_xor_b32 s15, s34, s2
    s_and_b32 s15, s15, 1
    s_lshl_b32 s15, s15, 13
    s_or_b32 s14, s14, s15
    s_xor_b32 s19, s19, s2
    s_and_b32 s19, s19, 1
    s_mul_i32 s19, s19, 5
    s_add_u32 s14, s14, 0x1c0000
    s_mov_b32 s15, 0
L_test:
    s_bitcmp1_b32 0x4c, s15
    s_cselect_b32 s16, 0x200000, 0
    s_cselect_b32 s21, 5, 0
    s_add_u32 s16, s16, s14
    s_xor_b32 s17, s16, 0x2000
    s_xor_b32 s21, s21, s19
    s_bitcmp1_b32 0x6a, s15
    s_cselect_b64 s[24:25], s[8:9], s[6:7]
    s_cselect_b32 s26, 14, 4
    s_mov_b32 s13, -1
    s_load_dword s12, s[24:25], s16 glc
    s_load_dword s13, s[24:25], s17 glc
    s_add_u32 s21, s21, s26
    s_lshl_b32 s21, 1, s21
    s_add_u32 s14, s14, 0x804300
    s_add_u32 s15, s15, 1
    s_waitcnt lgkmcnt(1)
    s_cmp_eq_u32 s13, -1
    s_cselect_b32 s21, s21, 0
    s_add_u32 s20, s20, s21
    s_waitcnt lgkmcnt(0)
    s_cmp_lt_u32 s15, 7
    s_cbranch_scc1 L_test
    s_atomic_add s20, s[28:29], 0x0 glc
    s_branch L_look
L_clear:
    s_mov_b32 s38, 1
    s_atomic_or s38, s[28:29], 0x4 glc
    v_mov_b32 v12, -1
    v_mov_b32 v13, -1
    v_mov_b32 v14, -1
    v_mov_b32 v15, -1
    v_and_b32 v1, 3, v2
    v_lshlrev_b32 v1, 4, v1
    v_lshrrev_b32 v4, 2, v2
    v_lshl_add_u32 v3, v4, 8, v1
    s_waitcnt lgkmcnt(0)
    s_cmp_lg_u32 s38, 0
    s_cbranch_scc1 L_look
    v_add_u32 v4, 0x80000, v3
    global_store_dwordx4 v4, v[12:15], s[30:31] sc1
    v_add_u32 v4, 0x81000, v3
    global_store_dwordx4 v4, v[12:15], s[30:31] sc1
    v_add_u32 v4, 0x82000, v3
    global_store_dwordx4 v4, v[12:15], s[30:31] sc1
    v_add_u32 v4, 0x83000, v3
    global_store_dwordx4 v4, v[12:15], s[30:31] sc1
    v_add_u32 v4, 0x84000, v3
    global_store_dwordx4 v4, v[12:15], s[30:31] sc1
    v_add_u32 v4, 0x85000, v3
    global_store_dwordx4 v4, v[12:15], s[30:31] sc1
    v_add_u32 v4, 0x86000, v3
    global_store_dwordx4 v4, v[12:15], s[30:31] sc1
    v_add_u32 v4, 0x87000, v3
    global_store_dwordx4 v4, v[12:15], s[30:31] sc1
    s_mov_b32 s38, 1
    s_waitcnt vmcnt(0)
    s_atomic_or s38, s[28:29], 0x8 glc
L_look:
L_hw1:
    ds_read_b32 v1, v10 offset:0
    s_sub_u32 s40, s40, 1
    s_cbranch_scc1 L_exit
    s_waitcnt lgkmcnt(0)
    v_readfirstlane_b32 s23, v1
    s_cmp_ge_u32 s23, 16
    s_cbranch_scc0 L_hw1
    s_mov_b32 s42, 64
L_lookld:
    global_load_dwordx3 v[4:6], v0, s[28:29] sc1
    s_sub_u32 s40, s40, 8
    s_cbranch_scc1 L_exit
    s_waitcnt vmcnt(0)
    v_readfirstlane_b32 s36, v4
    v_readfirstlane_b32 s37, v5
    v_readfirstlane_b32 s38, v6
    s_and_b32 s12, s36, 0x80000008
    s_min_u32 s13, s12, s38
    s_cmp_lg_u32 s13, 0
    s_cbranch_scc1 L_placed
    s_sub_u32 s42, s42, 1
    s_cbranch_scc0 L_lookld
    s_mov_b32 s42, 0
    s_cmp_eq_u32 s37, 0
    s_cbranch_scc1 L_clear
    s_cmp_lg_u32 s12, 0
    s_cbranch_scc1 L_lookld
    s_or_b32 s12, s36, 0x80000000
    s_mov_b32 s13, s36
    s_atomic_cmpswap s[12:13], s[28:29], 0x0 glc
    s_waitcnt lgkmcnt(0)
    s_branch L_lookld
L_placed:
    s_bfe_u32 s12, s36, 0x50004
    s_bfe_u32 s13, s36, 0x50009
    s_sub_u32 s16, s12, s13
    s_bfe_u32 s12, s36, 0x5000e
    s_bfe_u32 s13, s36, 0x50013
    s_sub_u32 s17, s12, s13
    s_sub_u32 s13, 0, s17
    s_cmp_lt_i32 s16, 0
    s_cselect_b32 s17, s13, s17
    s_bfe_u32 s38, s36, 0x30018
    s_add_u32 s38, s38, s2
    s_lshr_b32 s39, s38, 2
    s_lshr_b32 s13, s16, 31
    s_xor_b32 s39, s39, s13
    s_lshr_b32 s50, s33, 6
    s_xor_b32 s39, s39, s50
    s_and_b32 s39, s39, 1
    s_lshl_b32 s39, s39, 13
    s_abs_i32 s12, s16
    s_cmp_ge_i32 s12, 4
    s_cselect_b32 s17, s17, 0
    s_bitcmp1_b32 s36, 31
    s_cselect_b32 s17, 0, s17
    s_cmp_ge_i32 s17, 3
    s_cselect_b32 s46, 1, 0
    s_movk_i32 s57, 80
    s_cselect_b32 s57, 80, s57
    s_cmp_le_i32 s17, -3
    s_cselect_b32 s59, 4, 0
    s_cselect_b32 s47, 1, 0
    s_and_b32 s13, s33, 0x78
    s_cmp_eq_u32 s13, 0x38
    s_cselect_b32 s47, s47, 0
    s_cmp_eq_u32 s47, 1
    s_cselect_b32 s59, -7, s59
    s_add_u32 s57, s57, s59
    s_or_b32 s37, s46, s47
    s_or_b32 s39, s39, s47
    v_mov_b32 v4, s37
    v_mov_b32 v5, s39
    v_mov_b32 v6, s57
    ds_write_b32 v10, v5 offset:28
    ds_write_b32 v10, v6 offset:20
    ds_write_b32 v10, v4 offset:24
    s_and_b32 s48, s2, 7
    v_add_u32 v8, 4, v2
    v_mul_u32_u24 v8, s48, v8
    v_add_u32 v8, s49, v8
    v_and_b32 v8, 31, v8
    v_lshl_add_u32 v8, v2, 5, v8
    v_lshlrev_b32 v8, 8, v8
    v_add_u32 v8, 0x88000, v8
    s_and_b32 s54, s49, 15
    s_add_u32 s54, s54, 20
L_hw2:
    ds_read_b32 v1, v10 offset:0
    s_sub_u32 s40, s40, 1
    s_cbranch_scc1 L_exit
    s_waitcnt lgkmcnt(0)
    v_readfirstlane_b32 s23, v1
    s_cmp_ge_u32 s23, s54
    s_cbranch_scc0 L_hw2
    s_mov_b64 exec, 0xff
    global_load_dword v9, v8, s[30:31] sc1
    s_mov_b64 exec, -1
    s_mul_i32 s58, s32, -2
    s_add_u32 s58, s58, 1
    s_mul_i32 s54, s32, 0
    s_add_u32 s54, s54, 64
    s_cmp_eq_u32 s46, 1
    s_mov_b32 s44, 0x4f4e4c4a
    s_cselect_b32 s44, 0x4f4e4c4a, s44
    s_mov_b32 s45, 0x56545251
    s_cselect_b32 s45, 0x56545251, s45
    s_waitcnt vmcnt(0)
    v_readlane_b32 s52, v8, 0
    v_readlane_b32 s53, v9, 0
L_hw3:
    ds_read_b32 v1, v10 offset:0
    s_sub_u32 s40, s40, 1
    s_cbranch_scc1 L_exit
    s_waitcnt lgkmcnt(0)
    v_readfirstlane_b32 s23, v1
    s_cmp_ge_u32 s23, s54
    s_cbranch_scc0 L_hw3
    s_mov_b32 s55, 1
    s_atomic_add s55, s[30:31], s52 glc
    s_waitcnt lgkmcnt(0)
    s_sub_u32 s55, s55, s53
    s_min_u32 s55, s55, 7
    s_lshl_b32 s55, s55, 3
    s_lshr_b64 s[56:57], s[44:45], s55
    s_and_b32 s56, s56, 0xff
    s_add_u32 s56, s56, s59
    v_mov_b32 v6, s56
    ds_write_b32 v10, v6 offset:20
    s_mul_i32 s54, s32, 0
    s_add_u32 s54, s54, 104
    v_readlane_b32 s52, v8, 1
    v_readlane_b32 s53, v9, 1
L_hw4:
    ds_read_b32 v1, v10 offset:0
    s_sub_u32 s40, s40, 1
    s_cbranch_scc1 L_exit
    s_waitcnt lgkmcnt(0)
    v_readfirstlane_b32 s23, v1
    s_cmp_ge_u32 s23, s54
    s_cbranch_scc0 L_hw4
    s_mov_b32 s55, 1
    s_atomic_add s55, s[30:31], s52 glc
    s_waitcnt lgkmcnt(0)
    s_sub_u32 s55, s55, s53
    s_min_u32 s55, s55, 7
    s_lshl_b32 s55, s55, 3
    s_lshr_b64 s[56:57], s[44:45], s55
    s_and_b32 s56, s56, 0xff
    s_add_u32 s56, s56, s59
    v_mov_b32 v6, s56
    ds_write_b32 v10, v6 offset:20
    s_mul_i32 s54, s32, 0
    s_add_u32 s54, s54, 128
    v_readlane_b32 s52, v8, 2
    v_readlane_b32 s53, v9, 2
L_hw5:
    ds_read_b32 v1, v10 offset:0
    s_sub_u32 s40, s40, 1
    s_cbranch_scc1 L_exit
    s_waitcnt lgkmcnt(0)
    v_readfirstlane_b32 s23, v1
    s_cmp_ge_u32 s23, s54
    s_cbranch_scc0 L_hw5
    s_mov_b32 s55, 1
    s_atomic_add s55, s[30:31], s52 glc
    s_waitcnt lgkmcnt(0)
    s_sub_u32 s55, s55, s53
    s_min_u32 s55, s55, 7
    s_lshl_b32 s55, s55, 3
    s_lshr_b64 s[56:57], s[44:45], s55
    s_and_b32 s56, s56, 0xff
    s_add_u32 s56, s56, s59
    s_add_u32 s56, s56, s58
    s_max_i32 s13, s59, 0
    s_sub_u32 s13, s56, s13
    v_mov_b32 v6, s13
    ds_write_b32 v10, v6 offset:20
    s_cmp_eq_u32 s47, 0
    s_cbranch_scc1 L_fetched
    v_lshlrev_b32 v4, 4, v2
    s_xor_b32 s35, s2, 4
    s_lshl_b32 s35, s35, 15
    s_add_u32 s35, s35, 0x101000
    v_add_u32 v3, s35, v4
    v_add_u32 v4, 92160, v4
    v_and_b32 v7, 3, v2
    v_lshlrev_b32 v7, 2, v7
    s_lshl_b32 s36, s33, 8
    s_lshl4_add_u32 s36, s34, s36
    s_add_u32 s36, s36, 0x80020
    v_add_u32 v5, s36, v7
    v_add_u32 v7, v10, v7
L_hw6:
    ds_read_b32 v1, v10 offset:16
    s_sub_u32 s40, s40, 1
    s_cbranch_scc1 L_exit
    s_waitcnt lgkmcnt(0)
    v_readfirstlane_b32 s23, v1
    s_cmp_ge_u32 s23, 129
    s_cbranch_scc0 L_hw6
    ds_read_b32 v12, v7 offset:64
    ds_read_b128 v[16:19], v4 offset:0
    ds_read_b128 v[20:23], v4 offset:1024
    ds_read_b128 v[24:27], v4 offset:2048
    ds_read_b128 v[28:31], v4 offset:3072
    ds_read_b128 v[32:35], v4 offset:4096
    ds_read_b128 v[36:39], v4 offset:5120
    ds_read_b128 v[40:43], v4 offset:6144
    ds_read_b128 v[44:47], v4 offset:7168
    s_waitcnt lgkmcnt(0)
    v_sub_f32 v16, v16, v12
    v_sub_f32 v17, v17, v12
    v_sub_f32 v18, v18, v12
    v_sub_f32 v19, v19, v12
    v_sub_f32 v20, v20, v12
    v_sub_f32 v21, v21, v12
    v_sub_f32 v22, v22, v12
    v_sub_f32 v23, v23, v12
    v_cvt_pk_f16_f32 v48, v16, v17
    v_cvt_pk_f16_f32 v49, v18, v19
    v_cvt_pk_f16_f32 v50, v20, v21
    v_cvt_pk_f16_f32 v51, v22, v23
    v_sub_f32 v24, v24, v12
    v_sub_f32 v25, v25, v12
    v_sub_f32 v26, v26, v12
    v_sub_f32 v27, v27, v12
    v_sub_f32 v28, v28, v12
    v_sub_f32 v29, v29, v12
    v_sub_f32 v30, v30, v12
    v_sub_f32 v31, v31, v12
    v_cvt_pk_f16_f32 v52, v24, v25
    v_cvt_pk_f16_f32 v53, v26, v27
    v_cvt_pk_f16_f32 v54, v28, v29
    v_cvt_pk_f16_f32 v55, v30, v31
    v_sub_f32 v32, v32, v12
    v_sub_f32 v33, v33, v12
    v_sub_f32 v34, v34, v12
    v_sub_f32 v35, v35, v12
    v_sub_f32 v36, v36, v12
    v_sub_f32 v37, v37, v12
    v_sub_f32 v38, v38, v12
    v_sub_f32 v39, v39, v12
    v_cvt_pk_f16_f32 v56, v32, v33
    v_cvt_pk_f16_f32 v57, v34, v35
    v_cvt_pk_f16_f32 v58, v36, v37
    v_cvt_pk_f16_f32 v59, v38, v39
    v_sub_f32 v40, v40, v12
    v_sub_f32 v41, v41, v12
    v_sub_f32 v42, v42, v12
    v_sub_f32 v43, v43, v12
    v_sub_f32 v44, v44, v12
    v_sub_f32 v45, v45, v12
    v_sub_f32 v46, v46, v12
    v_sub_f32 v47, v47, v12
    v_cvt_pk_f16_f32 v60, v40, v41
    v_cvt_pk_f16_f32 v61, v42, v43
    v_cvt_pk_f16_f32 v62, v44, v45
    v_cvt_pk_f16_f32 v63, v46, v47
    ds_read_b128 v[16:19], v4 offset:8192
    ds_read_b128 v[20:23], v4 offset:9216
    ds_read_b128 v[24:27], v4 offset:10240
    ds_read_b128 v[28:31], v4 offset:11264
    ds_read_b128 v[32:35], v4 offset:12288
    ds_read_b128 v[36:39], v4 offset:13312
    ds_read_b128 v[40:43], v4 offset:14336
    ds_read_b128 v[44:47], v4 offset:15360
    s_waitcnt lgkmcnt(0)
    v_sub_f32 v16, v16, v12
    v_sub_f32 v17, v17, v12
    v_sub_f32 v18, v18, v12
    v_sub_f32 v19, v19, v12
    v_sub_f32 v20, v20, v12
    v_sub_f32 v21, v21, v12
    v_sub_f32 v22, v22, v12
    v_sub_f32 v23, v23, v12
    v_cvt_pk_f16_f32 v64, v16, v17
    v_cvt_pk_f16_f32 v65, v18, v19
    v_cvt_pk_f16_f32 v66, v20, v21
    v_cvt_pk_f16_f32 v67, v22, v23
    v_sub_f32 v24, v24, v12
    v_sub_f32 v25, v25, v12
    v_sub_f32 v26, v26, v12
    v_sub_f32 v27, v27, v12
    v_sub_f32 v28, v28, v12
    v_sub_f32 v29, v29, v12
    v_sub_f32 v30, v30, v12
    v_sub_f32 v31, v31, v12
    v_cvt_pk_f16_f32 v68, v24, v25
    v_cvt_pk_f16_f32 v69, v26, v27
    v_cvt_pk_f16_f32 v70, v28, v29
    v_cvt_pk_f16_f32 v71, v30, v31
    v_sub_f32 v32, v32, v12
    v_sub_f32 v33, v33, v12
    v_sub_f32 v34, v34, v12
    v_sub_f32 v35, v35, v12
    v_sub_f32 v36, v36, v12
    v_sub_f32 v37, v37, v12
    v_sub_f32 v38, v38, v12
    v_sub_f32 v39, v39, v12
    v_cvt_pk_f16_f32 v72, v32, v33
    v_cvt_pk_f16_f32 v73, v34, v35
    v_cvt_pk_f16_f32 v74, v36, v37
    v_cvt_pk_f16_f32 v75, v38, v39
    v_sub_f32 v40, v40, v12
    v_sub_f32 v41, v41, v12
    v_sub_f32 v42, v42, v12
    v_sub_f32 v43, v43, v12
    v_sub_f32 v44, v44, v12
    v_sub_f32 v45, v45, v12
    v_sub_f32 v46, v46, v12
    v_sub_f32 v47, v47, v12
    v_cvt_pk_f16_f32 v76, v40, v41
    v_cvt_pk_f16_f32 v77, v42, v43
    v_cvt_pk_f16_f32 v78, v44, v45
    v_cvt_pk_f16_f32 v79, v46, v47
    ds_read_b128 v[16:19], v4 offset:16384
    ds_read_b128 v[20:23], v4 offset:17408
    ds_read_b128 v[24:27], v4 offset:18432
    ds_read_b128 v[28:31], v4 offset:19456
    ds_read_b128 v[32:35], v4 offset:20480
    ds_read_b128 v[36:39], v4 offset:21504
    ds_read_b128 v[40:43], v4 offset:22528
    ds_read_b128 v[44:47], v4 offset:23552
    s_waitcnt lgkmcnt(0)
    v_sub_f32 v16, v16, v12
    v_sub_f32 v17, v17, v12
    v_sub_f32 v18, v18, v12
    v_sub_f32 v19, v19, v12
    v_sub_f32 v20, v20, v12
    v_sub_f32 v21, v21, v12
    v_sub_f32 v22, v22, v12
    v_sub_f32 v23, v23, v12
    v_cvt_pk_f16_f32 v80, v16, v17
    v_cvt_pk_f16_f32 v81, v18, v19
    v_cvt_pk_f16_f32 v82, v20, v21
    v_cvt_pk_f16_f32 v83, v22, v23
    v_sub_f32 v24, v24, v12
    v_sub_f32 v25, v25, v12
    v_sub_f32 v26, v26, v12
    v_sub_f32 v27, v27, v12
    v_sub_f32 v28, v28, v12
    v_sub_f32 v29, v29, v12
    v_sub_f32 v30, v30, v12
    v_sub_f32 v31, v31, v12
    v_cvt_pk_f16_f32 v84, v24, v25
    v_cvt_pk_f16_f32 v85, v26, v27
    v_cvt_pk_f16_f32 v86, v28, v29
    v_cvt_pk_f16_f32 v87, v30, v31
    v_sub_f32 v32, v32, v12
    v_sub_f32 v33, v33, v12
    v_sub_f32 v34, v34, v12
    v_sub_f32 v35, v35, v12
    v_sub_f32 v36, v36, v12
    v_sub_f32 v37, v37, v12
    v_sub_f32 v38, v38, v12
    v_sub_f32 v39, v39, v12
    v_cvt_pk_f16_f32 v88, v32, v33
    v_cvt_pk_f16_f32 v89, v34, v35
    v_cvt_pk_f16_f32 v90, v36, v37
    v_cvt_pk_f16_f32 v91, v38, v39
    v_sub_f32 v40, v40, v12
    v_sub_f32 v41, v41, v12
    v_sub_f32 v42, v42, v12
    v_sub_f32 v43, v43, v12
    v_sub_f32 v44, v44, v12
    v_sub_f32 v45, v45, v12
    v_sub_f32 v46, v46, v12
    v_sub_f32 v47, v47, v12
    v_cvt_pk_f16_f32 v92, v40, v41
    v_cvt_pk_f16_f32 v93, v42, v43
    v_cvt_pk_f16_f32 v94, v44, v45
    v_cvt_pk_f16_f32 v95, v46, v47
    ds_read_b128 v[16:19], v4 offset:24576
    ds_read_b128 v[20:23], v4 offset:25600
    ds_read_b128 v[24:27], v4 offset:26624
    ds_read_b128 v[28:31], v4 offset:27648
    ds_read_b128 v[32:35], v4 offset:28672
    ds_read_b128 v[36:39], v4 offset:29696
    ds_read_b128 v[40:43], v4 offset:30720
    ds_read_b128 v[44:47], v4 offset:31744
    s_waitcnt lgkmcnt(0)
    v_sub_f32 v16, v16, v12
    v_sub_f32 v17, v17, v12
    v_sub_f32 v18, v18, v12
    v_sub_f32 v19, v19, v12
    v_sub_f32 v20, v20, v12
    v_sub_f32 v21, v21, v12
    v_sub_f32 v22, v22, v12
    v_sub_f32 v23, v23, v12
    v_cvt_pk_f16_f32 v96, v16, v17
    v_cvt_pk_f16_f32 v97, v18, v19
    v_cvt_pk_f16_f32 v98, v20, v21
    v_cvt_pk_f16_f32 v99, v22, v23
    v_sub_f32 v24, v24, v12
    v_sub_f32 v25, v25, v12
    v_sub_f32 v26, v26, v12
    v_sub_f32 v27, v27, v12
    v_sub_f32 v28, v28, v12
    v_sub_f32 v29, v29, v12
    v_sub_f32 v30, v30, v12
    v_sub_f32 v31, v31, v12
    v_cvt_pk_f16_f32 v100, v24, v25
    v_cvt_pk_f16_f32 v101, v26, v27
    v_cvt_pk_f16_f32 v102, v28, v29
    v_cvt_pk_f16_f32 v103, v30, v31
    v_sub_f32 v32, v32, v12
    v_sub_f32 v33, v33, v12
    v_sub_f32 v34, v34, v12
    v_sub_f32 v35, v35, v12
    v_sub_f32 v36, v36, v12
    v_sub_f32 v37, v37, v12
    v_sub_f32 v38, v38, v12
    v_sub_f32 v39, v39, v12
    v_cvt_pk_f16_f32 v104, v32, v33
    v_cvt_pk_f16_f32 v105, v34, v35
    v_cvt_pk_f16_f32 v106, v36, v37
    v_cvt_pk_f16_f32 v107, v38, v39
    v_sub_f32 v40, v40, v12
    v_sub_f32 v41, v41, v12
    v_sub_f32 v42, v42, v12
    v_sub_f32 v43, v43, v12
    v_sub_f32 v44, v44, v12
    v_sub_f32 v45, v45, v12
    v_sub_f32 v46, v46, v12
    v_sub_f32 v47, v47, v12
    v_cvt_pk_f16_f32 v108, v40, v41
    v_cvt_pk_f16_f32 v109, v42, v43
    v_cvt_pk_f16_f32 v110, v44, v45
    v_cvt_pk_f16_f32 v111, v46, v47
    ds_read_b128 v[16:19], v4 offset:32768
    ds_read_b128 v[20:23], v4 offset:33792
    ds_read_b128 v[24:27], v4 offset:34816
    ds_read_b128 v[28:31], v4 offset:35840
    ds_read_b128 v[32:35], v4 offset:36864
    ds_read_b128 v[36:39], v4 offset:37888
    ds_read_b128 v[40:43], v4 offset:38912
    ds_read_b128 v[44:47], v4 offset:39936
    s_waitcnt lgkmcnt(0)
    v_sub_f32 v16, v16, v12
    v_sub_f32 v17, v17, v12
    v_sub_f32 v18, v18, v12
    v_sub_f32 v19, v19, v12
    v_sub_f32 v20, v20, v12
    v_sub_f32 v21, v21, v12
    v_sub_f32 v22, v22, v12
    v_sub_f32 v23, v23, v12
    v_cvt_pk_f16_f32 v112, v16, v17
    v_cvt_pk_f16_f32 v113, v18, v19
    v_cvt_pk_f16_f32 v114, v20, v21
    v_cvt_pk_f16_f32 v115, v22, v23
    v_sub_f32 v24, v24, v12
    v_sub_f32 v25, v25, v12
    v_sub_f32 v26, v26, v12
    v_sub_f32 v27, v27, v12
    v_sub_f32 v28, v28, v12
    v_sub_f32 v29, v29, v12
    v_sub_f32 v30, v30, v12
    v_sub_f32 v31, v31, v12
    v_cvt_pk_f16_f32 v116, v24, v25
    v_cvt_pk_f16_f32 v117, v26, v27
    v_cvt_pk_f16_f32 v118, v28, v29
    v_cvt_pk_f16_f32 v119, v30, v31
    v_sub_f32 v32, v32, v12
    v_sub_f32 v33, v33, v12
    v_sub_f32 v34, v34, v12
    v_sub_f32 v35, v35, v12
    v_sub_f32 v36, v36, v12
    v_sub_f32 v37, v37, v12
    v_sub_f32 v38, v38, v12
    v_sub_f32 v39, v39, v12
    v_cvt_pk_f16_f32 v120, v32, v33
    v_cvt_pk_f16_f32 v121, v34, v35
    v_cvt_pk_f16_f32 v122, v36, v37
    v_cvt_pk_f16_f32 v123, v38, v39
    v_sub_f32 v40, v40, v12
    v_sub_f32 v41, v41, v12
    v_sub_f32 v42, v42, v12
    v_sub_f32 v43, v43, v12
    v_sub_f32 v44, v44, v12
    v_sub_f32 v45, v45, v12
    v_sub_f32 v46, v46, v12
    v_sub_f32 v47, v47, v12
    v_cvt_pk_f16_f32 v124, v40, v41
    v_cvt_pk_f16_f32 v125, v42, v43
    v_cvt_pk_f16_f32 v126, v44, v45
    v_cvt_pk_f16_f32 v127, v46, v47
    ds_read_b128 v[16:19], v4 offset:40960
    ds_read_b128 v[20:23], v4 offset:41984
    ds_read_b128 v[24:27], v4 offset:43008
    ds_read_b128 v[28:31], v4 offset:44032
    ds_read_b128 v[32:35], v4 offset:45056
    ds_read_b128 v[36:39], v4 offset:46080
    ds_read_b128 v[40:43], v4 offset:47104
    ds_read_b128 v[44:47], v4 offset:48128
    s_waitcnt lgkmcnt(0)
    v_sub_f32 v16, v16, v12
    v_sub_f32 v17, v17, v12
    v_sub_f32 v18, v18, v12
    v_sub_f32 v19, v19, v12
    v_sub_f32 v20, v20, v12
    v_sub_f32 v21, v21, v12
    v_sub_f32 v22, v22, v12
    v_sub_f32 v23, v23, v12
    v_cvt_pk_f16_f32 v128, v16, v17
    v_cvt_pk_f16_f32 v129, v18, v19
    v_cvt_pk_f16_f32 v130, v20, v21
    v_cvt_pk_f16_f32 v131, v22, v23
    v_sub_f32 v24, v24, v12
    v_sub_f32 v25, v25, v12
    v_sub_f32 v26, v26, v12
    v_sub_f32 v27, v27, v12
    v_sub_f32 v28, v28, v12
    v_sub_f32 v29, v29, v12
    v_sub_f32 v30, v30, v12
    v_sub_f32 v31, v31, v12
    v_cvt_pk_f16_f32 v132, v24, v25
    v_cvt_pk_f16_f32 v133, v26, v27
    v_cvt_pk_f16_f32 v134, v28, v29
    v_cvt_pk_f16_f32 v135, v30, v31
    v_sub_f32 v32, v32, v12
    v_sub_f32 v33, v33, v12
    v_sub_f32 v34, v34, v12
    v_sub_f32 v35, v35, v12
    v_sub_f32 v36, v36, v12
    v_sub_f32 v37, v37, v12
    v_sub_f32 v38, v38, v12
    v_sub_f32 v39, v39, v12
    v_cvt_pk_f16_f32 v136, v32, v33
    v_cvt_pk_f16_f32 v137, v34, v35
    v_cvt_pk_f16_f32 v138, v36, v37
    v_cvt_pk_f16_f32 v139, v38, v39
    v_sub_f32 v40, v40, v12
    v_sub_f32 v41, v41, v12
    v_sub_f32 v42, v42, v12
    v_sub_f32 v43, v43, v12
    v_sub_f32 v44, v44, v12
    v_sub_f32 v45, v45, v12
    v_sub_f32 v46, v46, v12
    v_sub_f32 v47, v47, v12
    v_cvt_pk_f16_f32 v140, v40, v41
    v_cvt_pk_f16_f32 v141, v42, v43
    v_cvt_pk_f16_f32 v142, v44, v45
    v_cvt_pk_f16_f32 v143, v46, v47
    ds_read_b128 v[16:19], v4 offset:49152
    ds_read_b128 v[20:23], v4 offset:50176
    ds_read_b128 v[24:27], v4 offset:51200
    ds_read_b128 v[28:31], v4 offset:52224
    ds_read_b128 v[32:35], v4 offset:53248
    ds_read_b128 v[36:39], v4 offset:54272
    s_waitcnt lgkmcnt(0)
    v_sub_f32 v16, v16, v12
    v_sub_f32 v17, v17, v12
    v_sub_f32 v18, v18, v12
    v_sub_f32 v19, v19, v12
    v_sub_f32 v20, v20, v12
    v_sub_f32 v21, v21, v12
    v_sub_f32 v22, v22, v12
    v_sub_f32 v23, v23, v12
    v_cvt_pk_f16_f32 v144, v16, v17
    v_cvt_pk_f16_f32 v145, v18, v19
    v_cvt_pk_f16_f32 v146, v20, v21
    v_cvt_pk_f16_f32 v147, v22, v23
    v_sub_f32 v24, v24, v12
    v_sub_f32 v25, v25, v12
    v_sub_f32 v26, v26, v12
    v_sub_f32 v27, v27, v12
    v_sub_f32 v28, v28, v12
    v_sub_f32 v29, v29, v12
    v_sub_f32 v30, v30, v12
    v_sub_f32 v31, v31, v12
    v_cvt_pk_f16_f32 v148, v24, v25
    v_cvt_pk_f16_f32 v149, v26, v27
    v_cvt_pk_f16_f32 v150, v28, v29
    v_cvt_pk_f16_f32 v151, v30, v31
    v_sub_f32 v32, v32, v12
    v_sub_f32 v33, v33, v12
    v_sub_f32 v34, v34, v12
    v_sub_f32 v35, v35, v12
    v_sub_f32 v36, v36, v12
    v_sub_f32 v37, v37, v12
    v_sub_f32 v38, v38, v12
    v_sub_f32 v39, v39, v12
    v_cvt_pk_f16_f32 v152, v32, v33
    v_cvt_pk_f16_f32 v153, v34, v35
    v_cvt_pk_f16_f32 v154, v36, v37
    v_cvt_pk_f16_f32 v155, v38, v39
    global_store_dwordx4 v3, v[48:51], s[30:31] offset:-4096 sc1
    global_store_dwordx4 v3, v[52:55], s[30:31] offset:-3072 sc1
    global_store_dwordx4 v3, v[56:59], s[30:31] offset:-2048 sc1
    global_store_dwordx4 v3, v[60:63], s[30:31] offset:-1024 sc1
    global_store_dwordx4 v3, v[64:67], s[30:31] offset:0 sc1
    global_store_dwordx4 v3, v[68:71], s[30:31] offset:1024 sc1
    global_store_dwordx4 v3, v[72:75], s[30:31] offset:2048 sc1
    global_store_dwordx4 v3, v[76:79], s[30:31] offset:3072 sc1
    v_add_u32 v3, 8192, v3
    global_store_dwordx4 v3, v[80:83], s[30:31] offset:-4096 sc1
    global_store_dwordx4 v3, v[84:87], s[30:31] offset:-3072 sc1
    global_store_dwordx4 v3, v[88:91], s[30:31] offset:-2048 sc1
    global_store_dwordx4 v3, v[92:95], s[30:31] offset:-1024 sc1
    global_store_dwordx4 v3, v[96:99], s[30:31] offset:0 sc1
    global_store_dwordx4 v3, v[100:103], s[30:31] offset:1024 sc1
    global_store_dwordx4 v3, v[104:107], s[30:31] offset:2048 sc1
    global_store_dwordx4 v3, v[108:111], s[30:31] offset:3072 sc1
    v_add_u32 v3, 8192, v3
    global_store_dwordx4 v3, v[112:115], s[30:31] offset:-4096 sc1
    global_store_dwordx4 v3, v[116:119], s[30:31] offset:-3072 sc1
    global_store_dwordx4 v3, v[120:123], s[30:31] offset:-2048 sc1
    global_store_dwordx4 v3, v[124:127], s[30:31] offset:-1024 sc1
    global_store_dwordx4 v3, v[128:131], s[30:31] offset:0 sc1
    global_store_dwordx4 v3, v[132:135], s[30:31] offset:1024 sc1
    global_store_dwordx4 v3, v[136:139], s[30:31] offset:2048 sc1
    global_store_dwordx4 v3, v[140:143], s[30:31] offset:3072 sc1
    v_add_u32 v3, 8192, v3
    global_store_dwordx4 v3, v[144:147], s[30:31] offset:-4096 sc1
    global_store_dwordx4 v3, v[148:151], s[30:31] offset:-3072 sc1
    global_store_dwordx4 v3, v[152:155], s[30:31] offset:-2048 sc1
    v_min_u32 v12, -2, v12
    s_mov_b64 exec, 15
    s_waitcnt vmcnt(0)
    global_store_dword v5, v12, s[30:31] sc1
    s_mov_b64 exec, -1
    v_xor_b32 v5, 16, v5
    s_lshl_b32 s35, s2, 15
    s_add_u32 s35, s35, 0x101000
    v_lshl_add_u32 v3, v2, 4, s35
L_maxpoll:
    global_load_dword v13, v5, s[30:31] sc1
    s_sub_u32 s40, s40, 8
    s_cbranch_scc1 L_exit
    s_waitcnt vmcnt(0)
    v_cmp_eq_u32 vcc, -1, v13
    s_cbranch_vccnz L_maxpoll
    ds_write_b32 v7, v13 offset:32
    global_load_dwordx4 v[48:51], v3, s[30:31] offset:-4096 sc1
    global_load_dwordx4 v[52:55], v3, s[30:31] offset:-3072 sc1
    global_load_dwordx4 v[56:59], v3, s[30:31] offset:-2048 sc1
    global_load_dwordx4 v[60:63], v3, s[30:31] offset:-1024 sc1
    global_load_dwordx4 v[64:67], v3, s[30:31] offset:0 sc1
    global_load_dwordx4 v[68:71], v3, s[30:31] offset:1024 sc1
    global_load_dwordx4 v[72:75], v3, s[30:31] offset:2048 sc1
    global_load_dwordx4 v[76:79], v3, s[30:31] offset:3072 sc1
    v_add_u32 v3, 8192, v3
    global_load_dwordx4 v[80:83], v3, s[30:31] offset:-4096 sc1
    s_waitcnt vmcnt(0)
    s_waitcnt lgkmcnt(0)
    v_fma_mix_f32 v16, v48, 1.0, v13 op_sel_hi:[1,0,0]
    v_fma_mix_f32 v17, v48, 1.0, v13 op_sel:[1,0,0] op_sel_hi:[1,0,0]
    v_fma_mix_f32 v18, v49, 1.0, v13 op_sel_hi:[1,0,0]
    v_fma_mix_f32 v19, v49, 1.0, v13 op_sel:[1,0,0] op_sel_hi:[1,0,0]
    v_fma_mix_f32 v20, v50, 1.0, v13 op_sel_hi:[1,0,0]
    v_fma_mix_f32 v21, v50, 1.0, v13 op_sel:[1,0,0] op_sel_hi:[1,0,0]
    v_fma_mix_f32 v22, v51, 1.0, v13 op_sel_hi:[1,0,0]
    v_fma_mix_f32 v23, v51, 1.0, v13 op_sel:[1,0,0] op_sel_hi:[1,0,0]
    ds_write_b128 v4, v[16:19] offset:0
    ds_write_b128 v4, v[20:23] offset:1024
    v_fma_mix_f32 v24, v52, 1.0, v13 op_sel_hi:[1,0,0]
    v_fma_mix_f32 v25, v52, 1.0, v13 op_sel:[1,0,0] op_sel_hi:[1,0,0]
    v_fma_mix_f32 v26, v53, 1.0, v13 op_sel_hi:[1,0,0]
    v_fma_mix_f32 v27, v53, 1.0, v13 op_sel:[1,0,0] op_sel_hi:[1,0,0]
    v_fma_mix_f32 v28, v54, 1.0, v13 op_sel_hi:[1,0,0]
    v_fma_mix_f32 v29, v54, 1.0, v13 op_sel:[1,0,0] op_sel_hi:[1,0,0]
    v_fma_mix_f32 v30, v55, 1.0, v13 op_sel_hi:[1,0,0]
    v_fma_mix_f32 v31, v55, 1.0, v13 op_sel:[1,0,0] op_sel_hi:[1,0,0]
    ds_write_b128 v4, v[24:27] offset:2048
    ds_write_b128 v4, v[28:31] offset:3072
    v_fma_mix_f32 v32, v56, 1.0, v13 op_sel_hi:[1,0,0]
    v_fma_mix_f32 v33, v56, 1.0, v13 op_sel:[1,0,0] op_sel_hi:[1,0,0]
    v_fma_mix_f32 v34, v57, 1.0, v13 op_sel_hi:[1,0,0]
    v_fma_mix_f32 v35, v57, 1.0, v13 op_sel:[1,0,0] op_sel_hi:[1,0,0]
    v_fma_mix_f32 v36, v58, 1.0, v13 op_sel_hi:[1,0,0]
    v_fma_mix_f32 v37, v58, 1.0, v13 op_sel:[1,0,0] op_sel_hi:[1,0,0]
    v_fma_mix_f32 v38, v59, 1.0, v13 op_sel_hi:[1,0,0]
    v_fma_mix_f32 v39, v59, 1.0, v13 op_sel:[1,0,0] op_sel_hi:[1,0,0]
    ds_write_b128 v4, v[32:35] offset:4096
    ds_write_b128 v4, v[36:39] offset:5120
    v_fma_mix_f32 v40, v60, 1.0, v13 op_sel_hi:[1,0,0]
    v_fma_mix_f32 v41, v60, 1.0, v13 op_sel:[1,0,0] op_sel_hi:[1,0,0]
    v_fma_mix_f32 v42, v61, 1.0, v13 op_sel_hi:[1,0,0]
    v_fma_mix_f32 v43, v61, 1.0, v13 op_sel:[1,0,0] op_sel_hi:[1,0,0]
    v_fma_mix_f32 v44, v62, 1.0, v13 op_sel_hi:[1,0,0]
    v_fma_mix_f32 v45, v62, 1.0, v13 op_sel:[1,0,0] op_sel_hi:[1,0,0]
    v_fma_mix_f32 v46, v63, 1.0, v13 op_sel_hi:[1,0,0]
    v_fma_mix_f32 v47, v63, 1.0, v13 op_sel:[1,0,0] op_sel_hi:[1,0,0]
    ds_write_b128 v4, v[40:43] offset:6144
    ds_write_b128 v4, v[44:47] offset:7168
    s_waitcnt lgkmcnt(0)
    v_fma_mix_f32 v16, v64, 1.0, v13 op_sel_hi:[1,0,0]
    v_fma_mix_f32 v17, v64, 1.0, v13 op_sel:[1,0,0] op_sel_hi:[1,0,0]
    v_fma_mix_f32 v18, v65, 1.0, v13 op_sel_hi:[1,0,0]
    v_fma_mix_f32 v19, v65, 1.0, v13 op_sel:[1,0,0] op_sel_hi:[1,0,0]
    v_fma_mix_f32 v20, v66, 1.0, v13 op_sel_hi:[1,0,0]
    v_fma_mix_f32 v21, v66, 1.0, v13 op_sel:[1,0,0] op_sel_hi:[1,0,0]
    v_fma_mix_f32 v22, v67, 1.0, v13 op_sel_hi:[1,0,0]
    v_fma_mix_f32 v23, v67, 1.0, v13 op_sel:[1,0,0] op_sel_hi:[1,0,0]
    ds_write_b128 v4, v[16:19] offset:8192
    ds_write_b128 v4, v[20:23] offset:9216
    v_fma_mix_f32 v24, v68, 1.0, v13 op_sel_hi:[1,0,0]
    v_fma_mix_f32 v25, v68, 1.0, v13 op_sel:[1,0,0] op_sel_hi:[1,0,0]
    v_fma_mix_f32 v26, v69, 1.0, v13 op_sel_hi:[1,0,0]
    v_fma_mix_f32 v27, v69, 1.0, v13 op_sel:[1,0,0] op_sel_hi:[1,0,0]
    v_fma_mix_f32 v28, v70, 1.0, v13 op_sel_hi:[1,0,0]
    v_fma_mix_f32 v29, v70, 1.0, v13 op_sel:[1,0,0] op_sel_hi:[1,0,0]
    v_fma_mix_f32 v30, v71, 1.0, v13 op_sel_hi:[1,0,0]
    v_fma_mix_f32 v31, v71, 1.0, v13 op_sel:[1,0,0] op_sel_hi:[1,0,0]
    ds_write_b128 v4, v[24:27] offset:10240
    ds_write_b128 v4, v[28:31] offset:11264
    v_fma_mix_f32 v32, v72, 1.0, v13 op_sel_hi:[1,0,0]
    v_fma_mix_f32 v33, v72, 1.0, v13 op_sel:[1,0,0] op_sel_hi:[1,0,0]
    v_fma_mix_f32 v34, v73, 1.0, v13 op_sel_hi:[1,0,0]
    v_fma_mix_f32 v35, v73, 1.0, v13 op_sel:[1,0,0] op_sel_hi:[1,0,0]
    v_fma_mix_f32 v36, v74, 1.0, v13 op_sel_hi:[1,0,0]
    v_fma_mix_f32 v37, v74, 1.0, v13 op_sel:[1,0,0] op_sel_hi:[1,0,0]
    v_fma_mix_f32 v38, v75, 1.0, v13 op_sel_hi:[1,0,0]
    v_fma_mix_f32 v39, v75, 1.0, v13 op_sel:[1,0,0] op_sel_hi:[1,0,0]
    ds_write_b128 v4, v[32:35] offset:12288
    ds_write_b128 v4, v[36:39] offset:13312
    v_fma_mix_f32 v40, v76, 1.0, v13 op_sel_hi:[1,0,0]
    v_fma_mix_f32 v41, v76, 1.0, v13 op_sel:[1,0,0] op_sel_hi:[1,0,0]
    v_fma_mix_f32 v42, v77, 1.0, v13 op_sel_hi:[1,0,0]
    v_fma_mix_f32 v43, v77, 1.0, v13 op_sel:[1,0,0] op_sel_hi:[1,0,0]
    v_fma_mix_f32 v44, v78, 1.0, v13 op_sel_hi:[1,0,0]
    v_fma_mix_f32 v45, v78, 1.0, v13 op_sel:[1,0,0] op_sel_hi:[1,0,0]
    v_fma_mix_f32 v46, v79, 1.0, v13 op_sel_hi:[1,0,0]
    v_fma_mix_f32 v47, v79, 1.0, v13 op_sel:[1,0,0] op_sel_hi:[1,0,0]
    ds_write_b128 v4, v[40:43] offset:14336
    ds_write_b128 v4, v[44:47] offset:15360
    s_waitcnt lgkmcnt(0)
    v_fma_mix_f32 v16, v80, 1.0, v13 op_sel_hi:[1,0,0]
    v_fma_mix_f32 v17, v80, 1.0, v13 op_sel:[1,0,0] op_sel_hi:[1,0,0]
    v_fma_mix_f32 v18, v81, 1.0, v13 op_sel_hi:[1,0,0]
    v_fma_mix_f32 v19, v81, 1.0, v13 op_sel:[1,0,0] op_sel_hi:[1,0,0]
    v_fma_mix_f32 v20, v82, 1.0, v13 op_sel_hi:[1,0,0]
    v_fma_mix_f32 v21, v82, 1.0, v13 op_sel:[1,0,0] op_sel_hi:[1,0,0]
    v_fma_mix_f32 v22, v83, 1.0, v13 op_sel_hi:[1,0,0]
    v_fma_mix_f32 v23, v83, 1.0, v13 op_sel:[1,0,0] op_sel_hi:[1,0,0]
    ds_write_b128 v4, v[16:19] offset:16384
    ds_write_b128 v4, v[20:23] offset:17408
    global_load_dwordx4 v[84:87], v3, s[30:31] offset:-3072 sc1
    global_load_dwordx4 v[88:91], v3, s[30:31] offset:-2048 sc1
    global_load_dwordx4 v[92:95], v3, s[30:31] offset:-1024 sc1
    global_load_dwordx4 v[96:99], v3, s[30:31] offset:0 sc1
    global_load_dwordx4 v[100:103], v3, s[30:31] offset:1024 sc1
    global_load_dwordx4 v[104:107], v3, s[30:31] offset:2048 sc1
    global_load_dwordx4 v[108:111], v3, s[30:31] offset:3072 sc1
    v_add_u32 v3, 8192, v3
    global_load_dwordx4 v[112:115], v3, s[30:31] offset:-4096 sc1
    global_load_dwordx4 v[116:119], v3, s[30:31] offset:-3072 sc1
    s_waitcnt vmcnt(0)
    v_fma_mix_f32 v24, v84, 1.0, v13 op_sel_hi:[1,0,0]
    v_fma_mix_f32 v25, v84, 1.0, v13 op_sel:[1,0,0] op_sel_hi:[1,0,0]
    v_fma_mix_f32 v26, v85, 1.0, v13 op_sel_hi:[1,0,0]
    v_fma_mix_f32 v27, v85, 1.0, v13 op_sel:[1,0,0] op_sel_hi:[1,0,0]
    v_fma_mix_f32 v28, v86, 1.0, v13 op_sel_hi:[1,0,0]
    v_fma_mix_f32 v29, v86, 1.0, v13 op_sel:[1,0,0] op_sel_hi:[1,0,0]
    v_fma_mix_f32 v30, v87, 1.0, v13 op_sel_hi:[1,0,0]
    v_fma_mix_f32 v31, v87, 1.0, v13 op_sel:[1,0,0] op_sel_hi:[1,0,0]
    ds_write_b128 v4, v[24:27] offset:18432
    ds_write_b128 v4, v[28:31] offset:19456
    v_fma_mix_f32 v32, v88, 1.0, v13 op_sel_hi:[1,0,0]
    v_fma_mix_f32 v33, v88, 1.0, v13 op_sel:[1,0,0] op_sel_hi:[1,0,0]
    v_fma_mix_f32 v34, v89, 1.0, v13 op_sel_hi:[1,0,0]
    v_fma_mix_f32 v35, v89, 1.0, v13 op_sel:[1,0,0] op_sel_hi:[1,0,0]
    v_fma_mix_f32 v36, v90, 1.0, v13 op_sel_hi:[1,0,0]
    v_fma_mix_f32 v37, v90, 1.0, v13 op_sel:[1,0,0] op_sel_hi:[1,0,0]
    v_fma_mix_f32 v38, v91, 1.0, v13 op_sel_hi:[1,0,0]
    v_fma_mix_f32 v39, v91, 1.0, v13 op_sel:[1,0,0] op_sel_hi:[1,0,0]
    ds_write_b128 v4, v[32:35] offset:20480
    ds_write_b128 v4, v[36:39] offset:21504
    v_fma_mix_f32 v40, v92, 1.0, v13 op_sel_hi:[1,0,0]
    v_fma_mix_f32 v41, v92, 1.0, v13 op_sel:[1,0,0] op_sel_hi:[1,0,0]
    v_fma_mix_f32 v42, v93, 1.0, v13 op_sel_hi:[1,0,0]
    v_fma_mix_f32 v43, v93, 1.0, v13 op_sel:[1,0,0] op_sel_hi:[1,0,0]
    v_fma_mix_f32 v44, v94, 1.0, v13 op_sel_hi:[1,0,0]
    v_fma_mix_f32 v45, v94, 1.0, v13 op_sel:[1,0,0] op_sel_hi:[1,0,0]
    v_fma_mix_f32 v46, v95, 1.0, v13 op_sel_hi:[1,0,0]
    v_fma_mix_f32 v47, v95, 1.0, v13 op_sel:[1,0,0] op_sel_hi:[1,0,0]
    ds_write_b128 v4, v[40:43] offset:22528
    ds_write_b128 v4, v[44:47] offset:23552
    s_waitcnt lgkmcnt(0)
    v_fma_mix_f32 v16, v96, 1.0, v13 op_sel_hi:[1,0,0]
    v_fma_mix_f32 v17, v96, 1.0, v13 op_sel:[1,0,0] op_sel_hi:[1,0,0]
    v_fma_mix_f32 v18, v97, 1.0, v13 op_sel_hi:[1,0,0]
    v_fma_mix_f32 v19, v97, 1.0, v13 op_sel:[1,0,0] op_sel_hi:[1,0,0]
    v_fma_mix_f32 v20, v98, 1.0, v13 op_sel_hi:[1,0,0]
    v_fma_mix_f32 v21, v98, 1.0, v13 op_sel:[1,0,0] op_sel_hi:[1,0,0]
    v_fma_mix_f32 v22, v99, 1.0, v13 op_sel_hi:[1,0,0]
    v_fma_mix_f32 v23, v99, 1.0, v13 op_sel:[1,0,0] op_sel_hi:[1,0,0]
    ds_write_b128 v4, v[16:19] offset:24576
    ds_write_b128 v4, v[20:23] offset:25600
    v_fma_mix_f32 v24, v100, 1.0, v13 op_sel_hi:[1,0,0]
    v_fma_mix_f32 v25, v100, 1.0, v13 op_sel:[1,0,0] op_sel_hi:[1,0,0]
    v_fma_mix_f32 v26, v101, 1.0, v13 op_sel_hi:[1,0,0]
    v_fma_mix_f32 v27, v101, 1.0, v13 op_sel:[1,0,0] op_sel_hi:[1,0,0]
    v_fma_mix_f32 v28, v102, 1.0, v13 op_sel_hi:[1,0,0]
    v_fma_mix_f32 v29, v102, 1.0, v13 op_sel:[1,0,0] op_sel_hi:[1,0,0]
    v_fma_mix_f32 v30, v103, 1.0, v13 op_sel_hi:[1,0,0]
    v_fma_mix_f32 v31, v103, 1.0, v13 op_sel:[1,0,0] op_sel_hi:[1,0,0]
    ds_write_b128 v4, v[24:27] offset:26624
    ds_write_b128 v4, v[28:31] offset:27648
    v_fma_mix_f32 v32, v104, 1.0, v13 op_sel_hi:[1,0,0]
    v_fma_mix_f32 v33, v104, 1.0, v13 op_sel:[1,0,0] op_sel_hi:[1,0,0]
    v_fma_mix_f32 v34, v105, 1.0, v13 op_sel_hi:[1,0,0]
    v_fma_mix_f32 v35, v105, 1.0, v13 op_sel:[1,0,0] op_sel_hi:[1,0,0]
    v_fma_mix_f32 v36, v106, 1.0, v13 op_sel_hi:[1,0,0]
    v_fma_mix_f32 v37, v106, 1.0, v13 op_sel:[1,0,0] op_sel_hi:[1,0,0]
    v_fma_mix_f32 v38, v107, 1.0, v13 op_sel_hi:[1,0,0]
    v_fma_mix_f32 v39, v107, 1.0, v13 op_sel:[1,0,0] op_sel_hi:[1,0,0]
    ds_write_b128 v4, v[32:35] offset:28672
    ds_write_b128 v4, v[36:39] offset:29696
    v_fma_mix_f32 v40, v108, 1.0, v13 op_sel_hi:[1,0,0]
    v_fma_mix_f32 v41, v108, 1.0, v13 op_sel:[1,0,0] op_sel_hi:[1,0,0]
    v_fma_mix_f32 v42, v109, 1.0, v13 op_sel_hi:[1,0,0]
    v_fma_mix_f32 v43, v109, 1.0, v13 op_sel:[1,0,0] op_sel_hi:[1,0,0]
    v_fma_mix_f32 v44, v110, 1.0, v13 op_sel_hi:[1,0,0]
    v_fma_mix_f32 v45, v110, 1.0, v13 op_sel:[1,0,0] op_sel_hi:[1,0,0]
    v_fma_mix_f32 v46, v111, 1.0, v13 op_sel_hi:[1,0,0]
    v_fma_mix_f32 v47, v111, 1.0, v13 op_sel:[1,0,0] op_sel_hi:[1,0,0]
    ds_write_b128 v4, v[40:43] offset:30720
    ds_write_b128 v4, v[44:47] offset:31744
    s_waitcnt lgkmcnt(0)
    v_fma_mix_f32 v16, v112, 1.0, v13 op_sel_hi:[1,0,0]
    v_fma_mix_f32 v17, v112, 1.0, v13 op_sel:[1,0,0] op_sel_hi:[1,0,0]
    v_fma_mix_f32 v18, v113, 1.0, v13 op_sel_hi:[1,0,0]
    v_fma_mix_f32 v19, v113, 1.0, v13 op_sel:[1,0,0] op_sel_hi:[1,0,0]
    v_fma_mix_f32 v20, v114, 1.0, v13 op_sel_hi:[1,0,0]
    v_fma_mix_f32 v21, v114, 1.0, v13 op_sel:[1,0,0] op_sel_hi:[1,0,0]
    v_fma_mix_f32 v22, v115, 1.0, v13 op_sel_hi:[1,0,0]
    v_fma_mix_f32 v23, v115, 1.0, v13 op_sel:[1,0,0] op_sel_hi:[1,0,0]
    ds_write_b128 v4, v[16:19] offset:32768
    ds_write_b128 v4, v[20:23] offset:33792
    v_fma_mix_f32 v24, v116, 1.0, v13 op_sel_hi:[1,0,0]
    v_fma_mix_f32 v25, v116, 1.0, v13 op_sel:[1,0,0] op_sel_hi:[1,0,0]
    v_fma_mix_f32 v26, v117, 1.0, v13 op_sel_hi:[1,0,0]
    v_fma_mix_f32 v27, v117, 1.0, v13 op_sel:[1,0,0] op_sel_hi:[1,0,0]
    v_fma_mix_f32 v28, v118, 1.0, v13 op_sel_hi:[1,0,0]
    v_fma_mix_f32 v29, v118, 1.0, v13 op_sel:[1,0,0] op_sel_hi:[1,0,0]
    v_fma_mix_f32 v30, v119, 1.0, v13 op_sel_hi:[1,0,0]
    v_fma_mix_f32 v31, v119, 1.0, v13 op_sel:[1,0,0] op_sel_hi:[1,0,0]
    ds_write_b128 v4, v[24:27] offset:34816
    ds_write_b128 v4, v[28:31] offset:35840
    global_load_dwordx4 v[120:123], v3, s[30:31] offset:-2048 sc1
    global_load_dwordx4 v[124:127], v3, s[30:31] offset:-1024 sc1
    global_load_dwordx4 v[128:131], v3, s[30:31] offset:0 sc1
    global_load_dwordx4 v[132:135], v3, s[30:31] offset:1024 sc1
    global_load_dwordx4 v[136:139], v3, s[30:31] offset:2048 sc1
    global_load_dwordx4 v[140:143], v3, s[30:31] offset:3072 sc1
    v_add_u32 v3, 8192, v3
    global_load_dwordx4 v[144:147], v3, s[30:31] offset:-4096 sc1
    global_load_dwordx4 v[148:151], v3, s[30:31] offset:-3072 sc1
    global_load_dwordx4 v[152:155], v3, s[30:31] offset:-2048 sc1
    s_waitcnt vmcnt(0)
    v_fma_mix_f32 v32, v120, 1.0, v13 op_sel_hi:[1,0,0]
    v_fma_mix_f32 v33, v120, 1.0, v13 op_sel:[1,0,0] op_sel_hi:[1,0,0]
    v_fma_mix_f32 v34, v121, 1.0, v13 op_sel_hi:[1,0,0]
    v_fma_mix_f32 v35, v121, 1.0, v13 op_sel:[1,0,0] op_sel_hi:[1,0,0]
    v_fma_mix_f32 v36, v122, 1.0, v13 op_sel_hi:[1,0,0]
    v_fma_mix_f32 v37, v122, 1.0, v13 op_sel:[1,0,0] op_sel_hi:[1,0,0]
    v_fma_mix_f32 v38, v123, 1.0, v13 op_sel_hi:[1,0,0]
    v_fma_mix_f32 v39, v123, 1.0, v13 op_sel:[1,0,0] op_sel_hi:[1,0,0]
    ds_write_b128 v4, v[32:35] offset:36864
    ds_write_b128 v4, v[36:39] offset:37888
    v_fma_mix_f32 v40, v124, 1.0, v13 op_sel_hi:[1,0,0]
    v_fma_mix_f32 v41, v124, 1.0, v13 op_sel:[1,0,0] op_sel_hi:[1,0,0]
    v_fma_mix_f32 v42, v125, 1.0, v13 op_sel_hi:[1,0,0]
    v_fma_mix_f32 v43, v125, 1.0, v13 op_sel:[1,0,0] op_sel_hi:[1,0,0]
    v_fma_mix_f32 v44, v126, 1.0, v13 op_sel_hi:[1,0,0]
    v_fma_mix_f32 v45, v126, 1.0, v13 op_sel:[1,0,0] op_sel_hi:[1,0,0]
    v_fma_mix_f32 v46, v127, 1.0, v13 op_sel_hi:[1,0,0]
    v_fma_mix_f32 v47, v127, 1.0, v13 op_sel:[1,0,0] op_sel_hi:[1,0,0]
    ds_write_b128 v4, v[40:43] offset:38912
    ds_write_b128 v4, v[44:47] offset:39936
    s_waitcnt lgkmcnt(0)
    v_fma_mix_f32 v16, v128, 1.0, v13 op_sel_hi:[1,0,0]
    v_fma_mix_f32 v17, v128, 1.0, v13 op_sel:[1,0,0] op_sel_hi:[1,0,0]
    v_fma_mix_f32 v18, v129, 1.0, v13 op_sel_hi:[1,0,0]
    v_fma_mix_f32 v19, v129, 1.0, v13 op_sel:[1,0,0] op_sel_hi:[1,0,0]
    v_fma_mix_f32 v20, v130, 1.0, v13 op_sel_hi:[1,0,0]
    v_fma_mix_f32 v21, v130, 1.0, v13 op_sel:[1,0,0] op_sel_hi:[1,0,0]
    v_fma_mix_f32 v22, v131, 1.0, v13 op_sel_hi:[1,0,0]
    v_fma_mix_f32 v23, v131, 1.0, v13 op_sel:[1,0,0] op_sel_hi:[1,0,0]
    ds_write_b128 v4, v[16:19] offset:40960
    ds_write_b128 v4, v[20:23] offset:41984
    v_fma_mix_f32 v24, v132, 1.0, v13 op_sel_hi:[1,0,0]
    v_fma_mix_f32 v25, v132, 1.0, v13 op_sel:[1,0,0] op_sel_hi:[1,0,0]
    v_fma_mix_f32 v26, v133, 1.0, v13 op_sel_hi:[1,0,0]
    v_fma_mix_f32 v27, v133, 1.0, v13 op_sel:[1,0,0] op_sel_hi:[1,0,0]
    v_fma_mix_f32 v28, v134, 1.0, v13 op_sel_hi:[1,0,0]
    v_fma_mix_f32 v29, v134, 1.0, v13 op_sel:[1,0,0] op_sel_hi:[1,0,0]
    v_fma_mix_f32 v30, v135, 1.0, v13 op_sel_hi:[1,0,0]
    v_fma_mix_f32 v31, v135, 1.0, v13 op_sel:[1,0,0] op_sel_hi:[1,0,0]
    ds_write_b128 v4, v[24:27] offset:43008
    ds_write_b128 v4, v[28:31] offset:44032
    v_fma_mix_f32 v32, v136, 1.0, v13 op_sel_hi:[1,0,0]
    v_fma_mix_f32 v33, v136, 1.0, v13 op_sel:[1,0,0] op_sel_hi:[1,0,0]
    v_fma_mix_f32 v34, v137, 1.0, v13 op_sel_hi:[1,0,0]
    v_fma_mix_f32 v35, v137, 1.0, v13 op_sel:[1,0,0] op_sel_hi:[1,0,0]
    v_fma_mix_f32 v36, v138, 1.0, v13 op_sel_hi:[1,0,0]
    v_fma_mix_f32 v37, v138, 1.0, v13 op_sel:[1,0,0] op_sel_hi:[1,0,0]
    v_fma_mix_f32 v38, v139, 1.0, v13 op_sel_hi:[1,0,0]
    v_fma_mix_f32 v39, v139, 1.0, v13 op_sel:[1,0,0] op_sel_hi:[1,0,0]
    ds_write_b128 v4, v[32:35] offset:45056
    ds_write_b128 v4, v[36:39] offset:46080
    v_fma_mix_f32 v40, v140, 1.0, v13 op_sel_hi:[1,0,0]
    v_fma_mix_f32 v41, v140, 1.0, v13 op_sel:[1,0,0] op_sel_hi:[1,0,0]
    v_fma_mix_f32 v42, v141, 1.0, v13 op_sel_hi:[1,0,0]
    v_fma_mix_f32 v43, v141, 1.0, v13 op_sel:[1,0,0] op_sel_hi:[1,0,0]
    v_fma_mix_f32 v44, v142, 1.0, v13 op_sel_hi:[1,0,0]
    v_fma_mix_f32 v45, v142, 1.0, v13 op_sel:[1,0,0] op_sel_hi:[1,0,0]
    v_fma_mix_f32 v46, v143, 1.0, v13 op_sel_hi:[1,0,0]
    v_fma_mix_f32 v47, v143, 1.0, v13 op_sel:[1,0,0] op_sel_hi:[1,0,0]
    ds_write_b128 v4, v[40:43] offset:47104
    ds_write_b128 v4, v[44:47] offset:48128
    s_waitcnt lgkmcnt(0)
    v_fma_mix_f32 v16, v144, 1.0, v13 op_sel_hi:[1,0,0]
    v_fma_mix_f32 v17, v144, 1.0, v13 op_sel:[1,0,0] op_sel_hi:[1,0,0]
    v_fma_mix_f32 v18, v145, 1.0, v13 op_sel_hi:[1,0,0]
    v_fma_mix_f32 v19, v145, 1.0, v13 op_sel:[1,0,0] op_sel_hi:[1,0,0]
    v_fma_mix_f32 v20, v146, 1.0, v13 op_sel_hi:[1,0,0]
    v_fma_mix_f32 v21, v146, 1.0, v13 op_sel:[1,0,0] op_sel_hi:[1,0,0]
    v_fma_mix_f32 v22, v147, 1.0, v13 op_sel_hi:[1,0,0]
    v_fma_mix_f32 v23, v147, 1.0, v13 op_sel:[1,0,0] op_sel_hi:[1,0,0]
    ds_write_b128 v4, v[16:19] offset:49152
    ds_write_b128 v4, v[20:23] offset:50176
    v_fma_mix_f32 v24, v148, 1.0, v13 op_sel_hi:[1,0,0]
    v_fma_mix_f32 v25, v148, 1.0, v13 op_sel:[1,0,0] op_sel_hi:[1,0,0]
    v_fma_mix_f32 v26, v149, 1.0, v13 op_sel_hi:[1,0,0]
    v_fma_mix_f32 v27, v149, 1.0, v13 op_sel:[1,0,0] op_sel_hi:[1,0,0]
    v_fma_mix_f32 v28, v150, 1.0, v13 op_sel_hi:[1,0,0]
    v_fma_mix_f32 v29, v150, 1.0, v13 op_sel:[1,0,0] op_sel_hi:[1,0,0]
    v_fma_mix_f32 v30, v151, 1.0, v13 op_sel_hi:[1,0,0]
    v_fma_mix_f32 v31, v151, 1.0, v13 op_sel:[1,0,0] op_sel_hi:[1,0,0]
    ds_write_b128 v4, v[24:27] offset:51200
    ds_write_b128 v4, v[28:31] offset:52224
    v_fma_mix_f32 v32, v152, 1.0, v13 op_sel_hi:[1,0,0]
    v_fma_mix_f32 v33, v152, 1.0, v13 op_sel:[1,0,0] op_sel_hi:[1,0,0]
    v_fma_mix_f32 v34, v153, 1.0, v13 op_sel_hi:[1,0,0]
    v_fma_mix_f32 v35, v153, 1.0, v13 op_sel:[1,0,0] op_sel_hi:[1,0,0]
    v_fma_mix_f32 v36, v154, 1.0, v13 op_sel_hi:[1,0,0]
    v_fma_mix_f32 v37, v154, 1.0, v13 op_sel:[1,0,0] op_sel_hi:[1,0,0]
    v_fma_mix_f32 v38, v155, 1.0, v13 op_sel_hi:[1,0,0]
    v_fma_mix_f32 v39, v155, 1.0, v13 op_sel:[1,0,0] op_sel_hi:[1,0,0]
    ds_write_b128 v4, v[32:35] offset:53248
    ds_write_b128 v4, v[36:39] offset:54272
    v_mov_b32 v1, 1
    ds_write_b32 v10, v1 offset:52
L_fetched:
L_hw7:
    ds_read_b32 v1, v10 offset:0
    s_sub_u32 s40, s40, 1
    s_cbranch_scc1 L_exit
    s_waitcnt lgkmcnt(0)
    v_readfirstlane_b32 s23, v1
    s_cmp_ge_u32 s23, 146
    s_cbranch_scc0 L_hw7
    v_mov_b32 v6, s56
    ds_write_b32 v10, v6 offset:20
    s_mul_i32 s54, s32, -1
    s_add_u32 s54, s54, 177
    s_cmp_eq_u32 s46, 1
    s_mov_b32 s44, 0x4f4d4b48
    s_cselect_b32 s44, 0x4b484542, s44
    s_mov_b32 s45, 0x5a555351
    s_cselect_b32 s45, 0x5753504d, s45
    v_readlane_b32 s52, v8, 3
    v_readlane_b32 s53, v9, 3
L_hw8:
    ds_read_b32 v1, v10 offset:0
    s_sub_u32 s40, s40, 1
    s_cbranch_scc1 L_exit
    s_waitcnt lgkmcnt(0)
    v_readfirstlane_b32 s23, v1
    s_cmp_ge_u32 s23, s54
    s_cbranch_scc0 L_hw8
    s_mov_b32 s55, 1
    s_atomic_add s55, s[30:31], s52 glc
    s_waitcnt lgkmcnt(0)
    s_sub_u32 s55, s55, s53
    s_min_u32 s55, s55, 7
    s_lshl_b32 s55, s55, 3
    s_lshr_b64 s[56:57], s[44:45], s55
    s_and_b32 s56, s56, 0xff
    s_add_u32 s56, s56, s59
    s_add_u32 s56, s56, s58
    v_mov_b32 v6, s56
    ds_write_b32 v10, v6 offset:20
    s_mul_i32 s54, s32, -2
    s_add_u32 s54, s54, 210
    v_readlane_b32 s52, v8, 4
    v_readlane_b32 s53, v9, 4
L_hw9:
    ds_read_b32 v1, v10 offset:0
    s_sub_u32 s40, s40, 1
    s_cbranch_scc1 L_exit
    s_waitcnt lgkmcnt(0)
    v_readfirstlane_b32 s23, v1
    s_cmp_ge_u32 s23, s54
    s_cbranch_scc0 L_hw9
    s_mov_b32 s55, 1
    s_atomic_add s55, s[30:31], s52 glc
    s_waitcnt lgkmcnt(0)
    s_sub_u32 s55, s55, s53
    s_min_u32 s55, s55, 7
    s_lshl_b32 s55, s55, 3
    s_lshr_b64 s[56:57], s[44:45], s55
    s_and_b32 s56, s56, 0xff
    s_add_u32 s56, s56, s59
    s_add_u32 s56, s56, s58
    v_mov_b32 v6, s56
    ds_write_b32 v10, v6 offset:20
    s_mul_i32 s54, s32, -2
    s_add_u32 s54, s54, 230
    v_readlane_b32 s52, v8, 5
    v_readlane_b32 s53, v9, 5
L_hw10:
    ds_read_b32 v1, v10 offset:0
    s_sub_u32 s40, s40, 1
    s_cbranch_scc1 L_exit
    s_waitcnt lgkmcnt(0)
    v_readfirstlane_b32 s23, v1
    s_cmp_ge_u32 s23, s54
    s_cbranch_scc0 L_hw10
    s_mov_b32 s55, 1
    s_atomic_add s55, s[30:31], s52 glc
    s_waitcnt lgkmcnt(0)
    s_sub_u32 s55, s55, s53
    s_min_u32 s55, s55, 7
    s_lshl_b32 s55, s55, 3
    s_lshr_b64 s[56:57], s[44:45], s55
    s_and_b32 s56, s56, 0xff
    s_add_u32 s56, s56, s59
    s_add_u32 s56, s56, s58
    v_mov_b32 v6, s56
    ds_write_b32 v10, v6 offset:20
    s_mul_i32 s54, s32, -3
    s_add_u32 s54, s54, 243
    v_readlane_b32 s52, v8, 6
    v_readlane_b32 s53, v9, 6
L_hw11:
    ds_read_b32 v1, v10 offset:0
    s_sub_u32 s40, s40, 1
    s_cbranch_scc1 L_exit
    s_waitcnt lgkmcnt(0)
    v_readfirstlane_b32 s23, v1
    s_cmp_ge_u32 s23, s54
    s_cbranch_scc0 L_hw11
    s_mov_b32 s55, 1
    s_atomic_add s55, s[30:31], s52 glc
    s_waitcnt lgkmcnt(0)
    s_sub_u32 s55, s55, s53
    s_min_u32 s55, s55, 7
    s_lshl_b32 s55, s55, 3
    s_lshr_b64 s[56:57], s[44:45], s55
    s_and_b32 s56, s56, 0xff
    s_add_u32 s56, s56, s59
    s_add_u32 s56, s56, s58
    v_mov_b32 v6, s56
    ds_write_b32 v10, v6 offset:20
    s_mul_i32 s54, s32, -3
    s_add_u32 s54, s54, 250
    v_readlane_b32 s52, v8, 7
    v_readlane_b32 s53, v9, 7
L_hw12:
    ds_read_b32 v1, v10 offset:0
    s_sub_u32 s40, s40, 1
    s_cbranch_scc1 L_exit
    s_waitcnt lgkmcnt(0)
    v_readfirstlane_b32 s23, v1
    s_cmp_ge_u32 s23, s54
    s_cbranch_scc0 L_hw12
    s_mov_b32 s55, 1
    s_atomic_add s55, s[30:31], s52 glc
    s_waitcnt lgkmcnt(0)
    s_sub_u32 s55, s55, s53
    s_min_u32 s55, s55, 7
    s_lshl_b32 s55, s55, 3
    s_lshr_b64 s[56:57], s[44:45], s55
    s_and_b32 s56, s56, 0xff
    s_add_u32 s56, s56, s59
    s_add_u32 s56, s56, s58
    v_mov_b32 v6, s56
    ds_write_b32 v10, v6 offset:20
    s_endpgm
.section .rodata,"a"
.p2align 6
.amdhsa_kernel standalone__softmax_full_bidir__sampling_kernel
  .amdhsa_next_free_vgpr 256
  .amdhsa_next_free_sgpr 102
  .amdhsa_accum_offset 256
  .amdhsa_group_segment_fixed_size 0
  .amdhsa_kernarg_size 48
  .amdhsa_user_sgpr_count 2
  .amdhsa_user_sgpr_kernarg_segment_ptr 1
  .amdhsa_system_sgpr_workgroup_id_x 1
.end_amdhsa_kernel
```
